```python
import torch

def _softmax(x, axis=-1):
    return torch.softmax(x, dim=axis)
def _gelu(x):
    return torch.nn.functional.gelu(x, approximate="tanh")
def _silu(x):
    return torch.nn.functional.silu(x)
def _sigmoid(x):
    return torch.sigmoid(x)
def _layernorm(x, axis=-1, eps=1e-5):
    m = x.mean(dim=axis, keepdim=True)
    v = x.var(dim=axis, keepdim=True, unbiased=False)
    return (x - m) / torch.sqrt(v + eps)
def _scatter_add(tgt, idx, src, axis=0):
    return tgt.clone().index_add_(axis, idx, src)
def _segment_sum(src, seg, n):
    out = torch.zeros((n,) + src.shape[1:], dtype=src.dtype)
    return out.index_add_(0, seg, src)
def _pad(x, pw):
    flat = tuple(v for pair in reversed(pw) for v in pair)
    return torch.nn.functional.pad(x, flat)

kernel_name = 'gated_mix__ssm_conv_s4d__mixer_channel_mlp__prompt'

def setup_inputs():

    _w = (lambda a: (lambda t: t.to(torch.bfloat16) if t.is_floating_point() else t)(torch.as_tensor(a)))
    def _A_setup():
        Bsz, L, D, N = 1, 2048, 640, 128
        return {
            "u": _w((lambda *s: torch.randn(*s, dtype=torch.bfloat16) * 0.05)(Bsz, L, D)),
            "log_A_real": _w((lambda *s: torch.randn(*s, dtype=torch.bfloat16) * 3.2)(D, N) * 0.5),
            "A_imag": _w((lambda *s: torch.randn(*s, dtype=torch.bfloat16) * 0.1)(D, N) * 3.14),
            "C_real": _w((lambda *s: torch.randn(*s, dtype=torch.bfloat16) * 0.8)(D, N) / N ** 0.5),
            "C_imag": _w((lambda *s: torch.randn(*s, dtype=torch.bfloat16) * 0.8)(D, N) / N ** 0.5),
            "log_dt": _w((lambda *s: torch.randn(*s, dtype=torch.bfloat16) * 0.1)(D) * 0.5 - 4.0),
            "D_skip": _w((lambda *s: torch.randn(*s, dtype=torch.bfloat16) * 0.1)(D)),
        }
    _A_in = _A_setup()

    def _B_setup():
        B, S, D, F = 1, 2048, 640, 1728
        return {
            "x": _w((lambda *s: torch.randn(*s, dtype=torch.bfloat16) * 0.05)(B, S, D)),
            "w1": _w((lambda *s: torch.randn(*s, dtype=torch.bfloat16) * 0.8)(D, F) * (D ** -0.5)),
            "b1": _w((lambda *s: torch.randn(*s, dtype=torch.bfloat16) * 0.4)(F)),
            "w2": _w((lambda *s: torch.randn(*s, dtype=torch.bfloat16) * 0.05)(F, D) * (F ** -0.5)),
            "b2": _w((lambda *s: torch.randn(*s, dtype=torch.bfloat16) * 0.05)(D)),
        }
    _B_in = _B_setup()

    return {
        "A_u": _A_in["u"],
        "A_log_A_real": _A_in["log_A_real"],
        "A_A_imag": _A_in["A_imag"],
        "A_C_real": _A_in["C_real"],
        "A_C_imag": _A_in["C_imag"],
        "A_log_dt": _A_in["log_dt"],
        "A_D_skip": _A_in["D_skip"],
        "B_x": _B_in["x"],
        "B_w1": _B_in["w1"],
        "B_b1": _B_in["b1"],
        "B_w2": _B_in["w2"],
        "B_b2": _B_in["b2"],
        "gate_w": _w((lambda *s: torch.randn(*s, dtype=torch.bfloat16) * 0.05)(640) * 16.0),
    }

def reference(A_u, A_log_A_real, A_A_imag, A_C_real, A_C_imag, A_log_dt, A_D_skip, B_x, B_w1, B_b1, B_w2, B_b2, gate_w):
    def _A_ref(u, log_A_real, A_imag, C_real, C_imag, log_dt, D_skip):
        L = u.shape[1]
        dt = torch.exp(log_dt)
        A = -torch.exp(log_A_real) + 1j * A_imag
        C = (C_real + 1j * C_imag) * dt[:, None]
        pos = (lambda x, dt: x.to(dt))(torch.arange(L), log_dt.dtype)
        P = torch.exp((A * dt[:, None])[:, :, None] * pos[None, None, :])
        K = 2.0 * torch.einsum("dn,dnl->dl", C, P).real
        L2 = 2 * L
        u_t = (lambda x, *d: x.permute(*d))(u, 0, 2, 1)
        Kf = (lambda x, *a, **k: torch.fft.rfft(x.float(), *a, **k))(K, L2)
        Uf = (lambda x, *a, **k: torch.fft.rfft(x.float(), *a, **k))(u_t, L2)
        y = (lambda x, *a, **k: torch.fft.irfft(x, *a, **k).to(torch.bfloat16))(Uf * Kf[None, :, :], L2)[:, :, :L]
        y = (lambda x, *d: x.permute(*d))(y, 0, 2, 1)
        return y + u * D_skip[None, None, :]

    def _B_ref(x, w1, b1, w2, b2):
        y = _layernorm(x, axis=-1)
        h = _gelu(torch.einsum("bsd,df->bsf", y, w1) + b1)
        return torch.einsum("bsf,fd->bsd", h, w2) + b2

    x = A_u
    g = _sigmoid((x * gate_w).sum(-1, keepdims=True))
    a = _A_ref(x, A_log_A_real, A_A_imag, A_C_real, A_C_imag, A_log_dt, A_D_skip)
    b = _B_ref(x, B_w1, B_b1, B_w2, B_b2)
    return g * a + (1 - g) * b
```

```asm
; @launch grid=(256,1,1) block=(512,1,1) lds=163840
.amdgcn_target "amdgcn-amd-amdhsa--gfx950"
.text
.globl gated_mix__ssm_conv_s4d__mixer_channel_mlp__prompt_kernel
.p2align 8
.type gated_mix__ssm_conv_s4d__mixer_channel_mlp__prompt_kernel,@function
gated_mix__ssm_conv_s4d__mixer_channel_mlp__prompt_kernel:
    s_cmp_ge_u32 s2, 256
    s_cbranch_scc1 gated_mix__ssm_conv_s4d__mixer_channel_mlp__prompt_kernel_end
    s_load_dwordx16 s[4:19], s[0:1], 0
    s_load_dwordx16 s[20:35], s[0:1], 64
    s_getpc_b64 s[66:67]
gated_mix__ssm_conv_s4d__mixer_channel_mlp__prompt_kernel_pc:
    v_lshlrev_b32 v1, 7, v0
    v_min_u32 v1, gated_mix__ssm_conv_s4d__mixer_channel_mlp__prompt_kernel_end-gated_mix__ssm_conv_s4d__mixer_channel_mlp__prompt_kernel_pc, v1
    global_load_dword v247, v1, s[66:67]
    v_lshrrev_b32 v1, 6, v0
    v_and_b32 v0, 63, v0
    v_readfirstlane_b32 s101, v1
    s_and_b32 s56, s2, 7
    s_lshr_b32 s57, s2, 3
    s_mul_i32 s66, s57, 37
    s_lshr_b32 s66, s66, 8
    s_mul_i32 s67, s66, 7
    s_sub_u32 s67, s57, s67
    s_lshr_b32 s58, s56, 1
    s_lshl2_add_u32 s58, s58, s66
    s_and_b32 s59, s56, 1
    s_mul_i32 s59, s59, 7
    s_add_u32 s59, s59, s67
    s_mul_i32 s66, s57, 3
    s_sub_u32 s66, s66, 56
    s_max_i32 s66, s66, s57
    s_mul_i32 s60, s56, 40
    s_add_u32 s60, s60, s66
    s_lshr_b32 s61, s57, 3
    s_lshl2_add_u32 s61, s56, s61
    s_and_b32 s62, s57, 7
    s_mov_b32 s63, 0x3f803f80
    s_mov_b32 s38, 2621440
    s_mov_b32 s39, 0x20000
    s_mov_b32 s42, 2211840
    s_mov_b32 s43, 0x20000
    s_mov_b32 s46, 17825792
    s_mov_b32 s47, 0x20000
    s_mov_b32 s50, 2211840
    s_mov_b32 s51, 0x20000
    s_mov_b32 s54, 2621440
    s_mov_b32 s55, 0x20000
    s_and_b32 s3, s101, 3
    s_lshr_b32 s100, s101, 2
    s_mov_b32 s94, 256
    s_mov_b32 s95, 0x20000
    s_cmp_eq_u32 s100, 0
    s_cbranch_scc1 gated_mix__ssm_conv_s4d__mixer_channel_mlp__prompt_kernel_c0
    s_cmp_ge_u32 s57, 28
    s_cbranch_scc1 gated_mix__ssm_conv_s4d__mixer_channel_mlp__prompt_kernel_fh
    v_lshrrev_b32 v2, 3, v0
    v_lshrrev_b32 v3, 4, v0
    v_xor_b32 v4, v0, v3
    v_and_b32 v4, 7, v4
    v_mul_u32_u24 v2, 1280, v2
    v_lshl_add_u32 v108, v4, 4, v2
    v_xor_b32 v109, 64, v108
    v_add_u32 v110, 18432, v108
    v_add_u32 v111, 27648, v109
    v_add_u32 v109, 9216, v109
    v_lshlrev_b32 v4, 2, v3
    v_xor_b32 v4, v0, v4
    v_and_b32 v4, 15, v4
    v_mul_u32_u24 v3, 3456, v3
    v_lshl_add_u32 v112, v4, 4, v3
    s_cmp_eq_u32 s59, 13
    s_cselect_b32 s66, 7, 15
    v_cmp_lt_u32 vcc, s66, v4
    v_mov_b32 v2, 1073741824
    s_lshl2_add_u32 s66, s58, s3
    s_mul_i32 s77, s66, 40960
    s_lshl_b32 s78, s59, 8
    s_mul_i32 s66, s3, 55296
    s_add_u32 s78, s78, s66
    s_lshl_b32 s80, s3, 12
    v_cndmask_b32 v112, v112, v2, vcc
    v_add_u32 v113, 12800, v112
    v_add_u32 v114, 25600, v112
    v_add_u32 v115, 38400, v112
    s_lshl2_add_u32 s66, s60, s3
    s_lshl_b32 s67, s66, 7
    v_lshl_add_u32 v70, v0, 1, s67
    s_and_b32 s66, s66, -2
    v_mov_b32 v71, s66
    s_waitcnt lgkmcnt(0)
    s_mov_b64 s[36:37], s[4:5]
    s_mov_b64 s[40:41], s[20:21]
    s_mov_b64 s[44:45], s[34:35]
    s_mov_b64 s[48:49], s[24:25]
    s_mov_b64 s[52:53], s[30:31]
    s_mov_b64 s[92:93], s[32:33]
    global_load_ushort v64, v70, s[6:7] offset:0
    global_load_ushort v65, v70, s[8:9] offset:0
    global_load_ushort v66, v70, s[10:11] offset:0
    global_load_ushort v67, v70, s[12:13] offset:0
    global_load_ushort v68, v71, s[14:15] offset:0
    global_load_ushort v69, v71, s[16:17] offset:0
    s_add_u32 m0, s80, 0
    s_nop 0
    buffer_load_dwordx4 v108, s[36:39], s77 offen offset:0 lds
    buffer_load_dwordx4 v109, s[36:39], s77 offen offset:1024 lds
    buffer_load_dwordx4 v110, s[36:39], s77 offen offset:2048 lds
    v_lshlrev_b32 v253, 4, v0
    s_cmp_ge_u32 s101, 6
    s_cselect_b32 s66, 1073741824, 0
    v_add_u32 v254, s66, v253
    s_mul_i32 s85, s62, 54
    s_add_u32 s85, s85, s101
    s_mul_i32 s85, s85, 5120
    s_add_u32 s85, s85, 7340032
    s_mov_b32 s64, 131072
    s_lshr_b32 s66, s3, 1
    s_mul_i32 s66, s66, 32736
    s_add_u32 s66, s66, 65536
    s_and_b32 s67, s3, 1
    s_lshl_b32 s67, s67, 8
    s_add_u32 s67, s67, s66
    buffer_load_dwordx4 v111, s[36:39], s77 offen offset:3072 lds
    v_lshl_add_u32 v52, v0, 2, s67
    v_and_b32 v58, 31, v0
    s_add_u32 m0, s80, 16384
    s_nop 0
    buffer_load_dwordx4 v112, s[40:43], s78 offen offset:0 lds
    v_lshrrev_b32 v59, 5, v0
    v_mul_u32_u24 v54, 528, v58
    buffer_load_dwordx4 v113, s[40:43], s78 offen offset:1024 lds
    v_lshl_add_u32 v54, v59, 4, v54
    v_add_u32 v54, s66, v54
    buffer_load_dwordx4 v114, s[40:43], s78 offen offset:2048 lds
    v_cmp_lt_u32 vcc, 27, v58
    v_subrev_u32 v53, 528, v54
    s_nop 0
    v_cndmask_b32 v53, v54, v53, vcc
    s_mul_i32 s66, s3, 4160
    s_add_u32 s66, s66, s64
    v_lshlrev_b32 v58, 4, v58
    v_sub_u32 v58, s66, v58
    v_lshlrev_b32 v57, 3, v59
    v_sub_u32 v55, v58, v57
    v_lshlrev_b32 v57, 9, v59
    v_sub_u32 v56, v58, v57
    v_and_b32 v57, 7, v0
    v_lshl_add_u32 v57, v57, 2, s66
    v_add_u32 v55, 3576, v55
    v_add_u32 v56, 1008, v56
    v_mov_b32 v58, 0x3f80
    s_waitcnt vmcnt(7)
    s_mov_b32 s66, 0x3fb8aa3b
    v_lshlrev_b32 v68, 16, v68
    v_lshlrev_b32 v64, 16, v64
    v_lshlrev_b32 v65, 16, v65
    v_mul_f32 v118, s66, v68
    v_mul_f32 v116, s66, v64
    v_lshlrev_b32 v67, 16, v67
    v_fma_f32 v119, v68, s66, -v118
    v_fma_f32 v117, v64, s66, -v116
    v_exp_f32 v118, v118
    v_fmac_f32 v119, 0x32a57060, v68
    v_fmac_f32 v117, 0x32a57060, v64
    v_exp_f32 v116, v116
    v_mul_f32 v119, 0x3f317218, v119
    buffer_load_dwordx4 v115, s[40:43], s78 offen offset:3072 lds
    v_mul_f32 v117, 0x3f317218, v117
    v_lshlrev_b32 v66, 16, v66
    v_fmac_f32 v118, v118, v119
    v_fmac_f32 v116, v116, v117
    v_lshlrev_b32 v69, 16, v69
    v_cvt_pk_bf16_f32 v118, v118, v118
    v_cvt_pk_bf16_f32 v116, v116, v116
    v_and_b32 v68, 0xffff0000, v118
    v_and_b32 v64, 0xffff0000, v116
    v_mul_f32 v117, v65, v68
    v_mul_f32 v116, v64, v68
    v_add_f32 v68, v68, v68
    v_mul_f32 v117, 0.15915494, v117
    v_mul_f32 v116, 0xbfb8aa3b, v116
    s_add_u32 m0, s80, 32768
    s_add_u32 s77, s77, 128
    buffer_load_dwordx4 v108, s[36:39], s77 offen offset:0 lds
    v_mul_f32 v178, v67, v68
    v_mul_f32 v143, 0x41800000, v117
    v_mul_f32 v147, 0x41000000, v117
    v_mul_f32 v142, 0x41800000, v116
    v_fract_f32 v143, v143
    v_mul_f32 v146, 0x41000000, v116
    v_fract_f32 v147, v147
    v_exp_f32 v142, v142
    v_cos_f32 v144, v143
    v_sin_f32 v145, v143
    v_exp_f32 v146, v146
    v_sin_f32 v149, v147
    v_cos_f32 v148, v147
    v_mul_f32 v126, v144, v142
    buffer_load_dwordx4 v109, s[36:39], s77 offen offset:1024 lds
    v_mul_f32 v127, v144, v142
    v_mul_f32 v199, v145, v142
    v_mul_f32 v198, v149, v146
    v_mul_f32 v197, v144, v142
    v_mul_f32 v128, v145, v142
    v_mul_f32 v129, v145, v142
    v_cvt_pk_bf16_f32 v13, v197, v199
    v_mul_f32 v130, v145, -v142
    v_mul_f32 v131, v145, -v142
    v_mul_f32 v196, v148, v146
    v_pk_mul_f32 v[210:211], v[198:199], v[126:127]
    v_mul_f32 v151, 0x40800000, v117
    v_cvt_pk_bf16_f32 v12, v196, v198
    v_pk_mul_f32 v[208:209], v[198:199], v[130:131]
    buffer_load_dwordx4 v110, s[36:39], s77 offen offset:2048 lds
    v_pk_fma_f32 v[202:203], v[196:197], v[128:129], v[210:211]
    v_mul_f32 v150, 0x40800000, v116
    v_fract_f32 v151, v151
    v_pk_fma_f32 v[200:201], v[196:197], v[126:127], v[208:209]
    v_pk_mul_f32 v[218:219], v[202:203], v[126:127]
    v_exp_f32 v150, v150
    v_cvt_pk_bf16_f32 v16, v200, v202
    v_cvt_pk_bf16_f32 v17, v201, v203
    v_cos_f32 v152, v151
    v_mul_f32 v155, 0x3f800000, v117
    v_pk_mul_f32 v[216:217], v[202:203], v[130:131]
    v_pk_fma_f32 v[206:207], v[200:201], v[128:129], v[218:219]
    v_sin_f32 v153, v151
    v_mul_f32 v154, 0x3f800000, v116
    buffer_load_dwordx4 v111, s[36:39], s77 offen offset:3072 lds
    v_fract_f32 v155, v155
    v_pk_fma_f32 v[204:205], v[200:201], v[126:127], v[216:217]
    v_pk_mul_f32 v[210:211], v[206:207], v[126:127]
    v_mul_f32 v138, v152, v150
    v_cvt_pk_bf16_f32 v20, v204, v206
    v_cvt_pk_bf16_f32 v21, v205, v207
    v_exp_f32 v154, v154
    v_cos_f32 v156, v155
    v_pk_mul_f32 v[208:209], v[206:207], v[130:131]
    v_pk_fma_f32 v[198:199], v[204:205], v[128:129], v[210:211]
    v_mul_f32 v176, v66, v68
    v_mul_f32 v139, v153, v150
    v_mul_f32 v141, v178, v138
    v_cvt_pk_bf16_f32 v14, v176, -v178
    s_add_u32 m0, s80, 49152
    s_add_u32 s78, s78, 221184
    buffer_load_dwordx4 v112, s[40:43], s78 offen offset:0 lds
    v_sin_f32 v157, v155
    v_pk_fma_f32 v[196:197], v[204:205], v[126:127], v[208:209]
    v_pk_mul_f32 v[218:219], v[198:199], v[126:127]
    v_mul_f32 v120, v156, v154
    v_cvt_pk_bf16_f32 v24, v196, v198
    v_cvt_pk_bf16_f32 v25, v197, v199
    v_mul_f32 v121, v156, v154
    v_mul_f32 v140, v178, v139
    v_fma_f32 v179, v176, v139, v141
    v_pk_mul_f32 v[216:217], v[198:199], v[130:131]
    v_pk_fma_f32 v[202:203], v[196:197], v[128:129], v[218:219]
    v_mul_f32 v122, v157, v154
    v_mul_f32 v123, v157, v154
    v_mul_f32 v124, v157, -v154
    buffer_load_dwordx4 v113, s[40:43], s78 offen offset:1024 lds
    v_mul_f32 v125, v157, -v154
    v_fma_f32 v177, v176, v138, -v140
    v_pk_mul_f32 v[214:215], v[178:179], v[120:121]
    v_pk_fma_f32 v[200:201], v[196:197], v[126:127], v[216:217]
    v_cvt_pk_bf16_f32 v15, v177, -v179
    v_pk_mul_f32 v[210:211], v[202:203], v[126:127]
    v_cvt_pk_bf16_f32 v28, v200, v202
    v_cvt_pk_bf16_f32 v29, v201, v203
    v_pk_mul_f32 v[212:213], v[178:179], v[124:125]
    v_pk_fma_f32 v[182:183], v[176:177], v[122:123], v[214:215]
    v_pk_mul_f32 v[208:209], v[202:203], v[130:131]
    v_pk_fma_f32 v[206:207], v[200:201], v[128:129], v[210:211]
    v_mul_f32 v159, 0x43800000, v117
    v_pk_fma_f32 v[180:181], v[176:177], v[120:121], v[212:213]
    buffer_load_dwordx4 v114, s[40:43], s78 offen offset:2048 lds
    v_pk_mul_f32 v[222:223], v[182:183], v[120:121]
    v_pk_fma_f32 v[204:205], v[200:201], v[126:127], v[208:209]
    v_cvt_pk_bf16_f32 v18, v180, -v182
    v_cvt_pk_bf16_f32 v19, v181, -v183
    v_cvt_pk_bf16_f32 v31, v204, v206
    v_cvt_pk_bf16_f32 v32, v205, v207
    v_pk_mul_f32 v[218:219], v[206:207], v[126:127]
    v_mul_f32 v158, 0x43800000, v116
    v_fract_f32 v159, v159
    v_pk_mul_f32 v[220:221], v[182:183], v[124:125]
    v_pk_fma_f32 v[186:187], v[180:181], v[122:123], v[222:223]
    v_pk_mul_f32 v[216:217], v[206:207], v[130:131]
    v_pk_fma_f32 v[198:199], v[204:205], v[128:129], v[218:219]
    v_exp_f32 v158, v158
    buffer_load_dwordx4 v115, s[40:43], s78 offen offset:3072 lds
    v_cos_f32 v160, v159
    v_pk_fma_f32 v[184:185], v[180:181], v[120:121], v[220:221]
    v_pk_mul_f32 v[214:215], v[186:187], v[120:121]
    v_pk_fma_f32 v[196:197], v[204:205], v[126:127], v[216:217]
    v_cvt_pk_bf16_f32 v22, v184, -v186
    v_cvt_pk_bf16_f32 v23, v185, -v187
    v_cvt_pk_bf16_f32 v35, v196, v198
    v_cvt_pk_bf16_f32 v36, v197, v199
    v_pk_mul_f32 v[210:211], v[198:199], v[126:127]
    v_sin_f32 v161, v159
    v_pk_mul_f32 v[212:213], v[186:187], v[124:125]
    v_pk_fma_f32 v[190:191], v[184:185], v[122:123], v[214:215]
    v_pk_mul_f32 v[208:209], v[198:199], v[130:131]
    v_pk_fma_f32 v[202:203], v[196:197], v[128:129], v[210:211]
    s_add_u32 m0, s80, 65536
    s_add_u32 s77, s77, 128
    buffer_load_dwordx4 v108, s[36:39], s77 offen offset:0 lds
    v_mul_f32 v132, v160, v158
    v_mul_f32 v133, v160, v158
    v_pk_fma_f32 v[188:189], v[184:185], v[120:121], v[212:213]
    v_pk_mul_f32 v[222:223], v[190:191], v[120:121]
    v_pk_fma_f32 v[200:201], v[196:197], v[126:127], v[208:209]
    v_cvt_pk_bf16_f32 v26, v188, -v190
    v_cvt_pk_bf16_f32 v27, v189, -v191
    v_cvt_pk_bf16_f32 v39, v200, v202
    v_cvt_pk_bf16_f32 v40, v201, v203
    v_pk_mul_f32 v[218:219], v[202:203], v[126:127]
    v_mul_f32 v134, v161, v158
    v_mul_f32 v135, v161, v158
    v_mul_f32 v136, v161, -v158
    v_mul_f32 v137, v161, -v158
    buffer_load_dwordx4 v109, s[36:39], s77 offen offset:1024 lds
    v_pk_mul_f32 v[214:215], v[178:179], v[132:133]
    v_pk_mul_f32 v[220:221], v[190:191], v[124:125]
    v_pk_fma_f32 v[194:195], v[188:189], v[122:123], v[222:223]
    v_pk_mul_f32 v[216:217], v[202:203], v[130:131]
    v_pk_fma_f32 v[206:207], v[200:201], v[128:129], v[218:219]
    v_pk_mul_f32 v[212:213], v[178:179], v[136:137]
    v_pk_fma_f32 v[226:227], v[176:177], v[134:135], v[214:215]
    v_pk_fma_f32 v[192:193], v[188:189], v[120:121], v[220:221]
    v_pk_mul_f32 v[222:223], v[186:187], v[132:133]
    v_pk_mul_f32 v[214:215], v[194:195], v[132:133]
    v_cvt_pk_bf16_f32 v30, v193, -v195
    v_pk_fma_f32 v[204:205], v[200:201], v[126:127], v[216:217]
    v_pk_mul_f32 v[210:211], v[206:207], v[126:127]
    v_pk_fma_f32 v[224:225], v[176:177], v[132:133], v[212:213]
    buffer_load_dwordx4 v110, s[36:39], s77 offen offset:2048 lds
    v_cvt_pk_bf16_f32 v42, v204, v206
    v_cvt_pk_bf16_f32 v43, v205, v207
    v_cvt_pk_bf16_f32 v33, v224, -v226
    v_cvt_pk_bf16_f32 v34, v225, -v227
    v_pk_mul_f32 v[220:221], v[186:187], v[136:137]
    v_pk_fma_f32 v[230:231], v[184:185], v[134:135], v[222:223]
    v_pk_mul_f32 v[212:213], v[194:195], v[136:137]
    v_pk_fma_f32 v[234:235], v[192:193], v[134:135], v[214:215]
    v_pk_mul_f32 v[222:223], v[226:227], v[132:133]
    v_pk_mul_f32 v[208:209], v[206:207], v[130:131]
    v_pk_fma_f32 v[198:199], v[204:205], v[128:129], v[210:211]
    v_pk_fma_f32 v[228:229], v[184:185], v[132:133], v[220:221]
    v_pk_fma_f32 v[232:233], v[192:193], v[132:133], v[212:213]
    v_pk_mul_f32 v[214:215], v[234:235], v[132:133]
    buffer_load_dwordx4 v111, s[36:39], s77 offen offset:3072 lds
    v_cvt_pk_bf16_f32 v37, v228, -v230
    v_cvt_pk_bf16_f32 v38, v229, -v231
    v_cvt_pk_bf16_f32 v41, v233, -v235
    v_pk_mul_f32 v[220:221], v[226:227], v[136:137]
    v_pk_fma_f32 v[238:239], v[224:225], v[134:135], v[222:223]
    v_pk_fma_f32 v[196:197], v[204:205], v[126:127], v[208:209]
    v_pk_mul_f32 v[218:219], v[198:199], v[126:127]
    v_pk_mul_f32 v[212:213], v[234:235], v[136:137]
    v_cvt_pk_bf16_f32 v46, v196, v198
    v_cvt_pk_bf16_f32 v47, v197, v199
    v_pk_fma_f32 v[242:243], v[232:233], v[134:135], v[214:215]
    v_pk_fma_f32 v[236:237], v[224:225], v[132:133], v[220:221]
    v_pk_mul_f32 v[216:217], v[198:199], v[130:131]
    v_pk_fma_f32 v[202:203], v[196:197], v[128:129], v[218:219]
    s_add_u32 m0, s80, 81920
    s_add_u32 s78, s78, 221184
    buffer_load_dwordx4 v112, s[40:43], s78 offen offset:0 lds
    v_cvt_pk_bf16_f32 v44, v236, -v238
    v_cvt_pk_bf16_f32 v45, v237, -v239
    v_pk_mul_f32 v[222:223], v[238:239], v[132:133]
    v_pk_fma_f32 v[240:241], v[232:233], v[132:133], v[212:213]
    v_pk_mul_f32 v[214:215], v[242:243], v[132:133]
    v_pk_fma_f32 v[200:201], v[196:197], v[126:127], v[216:217]
    v_cvt_pk_bf16_f32 v48, v241, -v243
    v_pk_mul_f32 v[220:221], v[238:239], v[136:137]
    v_cvt_pk_bf16_f32 v49, v200, v202
    v_cvt_pk_bf16_f32 v50, v201, v203
    v_pk_fma_f32 v[178:179], v[236:237], v[134:135], v[222:223]
    v_pk_mul_f32 v[210:211], v[202:203], v[126:127]
    v_pk_mul_f32 v[212:213], v[242:243], v[136:137]
    v_pk_fma_f32 v[182:183], v[240:241], v[134:135], v[214:215]
    buffer_load_dwordx4 v113, s[40:43], s78 offen offset:1024 lds
    v_pk_fma_f32 v[176:177], v[236:237], v[132:133], v[220:221]
    v_pk_mul_f32 v[208:209], v[202:203], v[130:131]
    v_pk_fma_f32 v[206:207], v[200:201], v[128:129], v[210:211]
    v_cvt_pk_bf16_f32 v51, v176, -v178
    v_cvt_pk_bf16_f32 v80, v177, -v179
    v_mov_b32 v182, v178
    v_pk_fma_f32 v[180:181], v[240:241], v[132:133], v[212:213]
    v_pk_fma_f32 v[204:205], v[200:201], v[126:127], v[208:209]
    v_mov_b32 v180, v176
    v_cvt_pk_bf16_f32 v83, v181, -v183
    v_cvt_pk_bf16_f32 v81, v204, v206
    v_cvt_pk_bf16_f32 v82, v205, v207
    v_pk_mul_f32 v[218:219], v[206:207], v[126:127]
    v_pk_mul_f32 v[222:223], v[182:183], v[132:133]
    buffer_load_dwordx4 v114, s[40:43], s78 offen offset:2048 lds
    v_pk_mul_f32 v[216:217], v[206:207], v[130:131]
    v_pk_fma_f32 v[198:199], v[204:205], v[128:129], v[218:219]
    v_pk_mul_f32 v[220:221], v[182:183], v[136:137]
    v_pk_fma_f32 v[186:187], v[180:181], v[134:135], v[222:223]
    v_pk_fma_f32 v[196:197], v[204:205], v[126:127], v[216:217]
    v_pk_fma_f32 v[184:185], v[180:181], v[132:133], v[220:221]
    v_pk_mul_f32 v[210:211], v[198:199], v[126:127]
    v_cvt_pk_bf16_f32 v84, v196, v198
    v_cvt_pk_bf16_f32 v85, v197, v199
    v_cvt_pk_bf16_f32 v86, v184, -v186
    v_cvt_pk_bf16_f32 v87, v185, -v187
    v_pk_mul_f32 v[214:215], v[186:187], v[132:133]
    v_pk_mul_f32 v[208:209], v[198:199], v[130:131]
    v_pk_fma_f32 v[202:203], v[196:197], v[128:129], v[210:211]
    buffer_load_dwordx4 v115, s[40:43], s78 offen offset:3072 lds
    v_pk_mul_f32 v[212:213], v[186:187], v[136:137]
    v_pk_fma_f32 v[190:191], v[184:185], v[134:135], v[214:215]
    v_pk_fma_f32 v[200:201], v[196:197], v[126:127], v[208:209]
    v_pk_fma_f32 v[188:189], v[184:185], v[132:133], v[212:213]
    v_pk_mul_f32 v[218:219], v[202:203], v[126:127]
    v_cvt_pk_bf16_f32 v88, v200, v202
    v_cvt_pk_bf16_f32 v89, v201, v203
    v_cvt_pk_bf16_f32 v90, v188, -v190
    v_cvt_pk_bf16_f32 v91, v189, -v191
    v_pk_mul_f32 v[222:223], v[190:191], v[132:133]
    v_pk_mul_f32 v[216:217], v[202:203], v[130:131]
    v_pk_fma_f32 v[206:207], v[200:201], v[128:129], v[218:219]
    v_pk_mul_f32 v[220:221], v[190:191], v[136:137]
    v_pk_fma_f32 v[194:195], v[188:189], v[134:135], v[222:223]
    s_barrier
    s_add_u32 m0, s80, 98304
    s_add_u32 s77, s77, 128
    buffer_load_dwordx4 v108, s[36:39], s77 offen offset:0 lds
    v_pk_fma_f32 v[204:205], v[200:201], v[126:127], v[216:217]
    v_pk_fma_f32 v[192:193], v[188:189], v[132:133], v[220:221]
    v_pk_mul_f32 v[208:209], v[206:207], v[130:131]
    v_cvt_pk_bf16_f32 v92, v204, v206
    v_cvt_pk_bf16_f32 v93, v205, v207
    v_cvt_pk_bf16_f32 v94, v192, -v194
    v_cvt_pk_bf16_f32 v95, v193, -v195
    v_pk_mul_f32 v[210:211], v[206:207], v[126:127]
    v_pk_mul_f32 v[212:213], v[194:195], v[136:137]
    v_pk_mul_f32 v[214:215], v[194:195], v[132:133]
    v_pk_fma_f32 v[196:197], v[204:205], v[126:127], v[208:209]
    v_pk_fma_f32 v[198:199], v[204:205], v[128:129], v[210:211]
    v_pk_fma_f32 v[180:181], v[192:193], v[132:133], v[212:213]
    v_pk_fma_f32 v[182:183], v[192:193], v[134:135], v[214:215]
    buffer_load_dwordx4 v109, s[36:39], s77 offen offset:1024 lds
    v_cvt_pk_bf16_f32 v96, v196, v198
    v_cvt_pk_bf16_f32 v97, v180, -v182
    v_cvt_pk_bf16_f32 v98, v181, -v183
    v_bfe_u32 v1, v0, 2, 1
    v_mul_u32_u24 v1, 4608, v1
    v_lshrrev_b32 v3, 3, v0
    v_lshl_add_u32 v1, v3, 6, v1
    v_and_b32 v3, 3, v0
    v_lshl_add_u32 v1, v3, 4, v1
    s_lshl_b32 s66, s3, 10
    s_add_u32 s66, s66, 148224
    v_add_u32 v1, s66, v1
    s_lshr_b32 s74, s3, 1
    s_and_b32 s75, s3, 1
    s_mul_i32 s66, s74, 4608
    s_add_u32 s66, s66, 147712
    s_lshl_b32 s70, s75, 8
    s_add_u32 s67, s66, s70
    v_lshl_add_u32 v2, v0, 2, s67
    s_sub_u32 s66, s66, s70
    s_add_u32 s66, s66, 288
    v_and_b32 v9, 15, v0
    v_lshrrev_b32 v10, 4, v0
    v_lshl_add_u32 v3, v9, 5, s66
    s_waitcnt vmcnt(18)
    s_barrier
    buffer_load_dwordx4 v110, s[36:39], s77 offen offset:2048 lds
    v_lshl_add_u32 v3, v10, 4, v3
    s_mul_i32 s66, s74, 8320
    s_add_u32 s66, s66, s64
    s_sub_u32 s66, s66, s70
    s_add_u32 s66, s66, 7520
    v_and_b32 v7, 1, v0
    v_mul_u32_u24 v7, 4164, v7
    v_and_b32 v4, 14, v0
    v_lshl_add_u32 v7, v4, 1, v7
    v_sub_u32 v7, s66, v7
    v_lshl_add_u32 v4, v10, 4, v7
    v_subrev_u32 v5, 1024, v4
    v_subrev_u32 v6, 2048, v4
    v_subrev_u32 v7, 3072, v4
    v_lshlrev_b32 v8, 6, v9
    v_lshl_add_u32 v8, v10, 4, v8
    v_mov_b32 v11, 0
    s_mul_i32 s66, s3, 4096
    s_add_u32 s66, s66, 0
    v_lshl_add_u32 v9, v0, 4, s66
    s_xor_b32 s66, s3, 1
    s_mul_i32 s66, s66, 4096
    s_add_u32 s66, s66, 0
    buffer_load_dwordx4 v111, s[36:39], s77 offen offset:3072 lds
    v_lshl_add_u32 v10, v0, 4, s66
    s_add_u32 m0, s80, 114688
    s_add_u32 s78, s78, 221184
    buffer_load_dwordx4 v112, s[40:43], s78 offen offset:0 lds
    buffer_load_dwordx4 v113, s[40:43], s78 offen offset:1024 lds
    buffer_load_dwordx4 v114, s[40:43], s78 offen offset:2048 lds
    buffer_load_dwordx4 v115, s[40:43], s78 offen offset:3072 lds
    s_waitcnt vmcnt(16)
    s_barrier
    s_add_u32 m0, s80, 0
    s_add_u32 s77, s77, 128
    buffer_load_dwordx4 v108, s[36:39], s77 offen offset:0 lds
    buffer_load_dwordx4 v109, s[36:39], s77 offen offset:1024 lds
    buffer_load_dwordx4 v110, s[36:39], s77 offen offset:2048 lds
    buffer_load_dwordx4 v111, s[36:39], s77 offen offset:3072 lds
    s_add_u32 m0, s80, 16384
    s_add_u32 s78, s78, 221184
    buffer_load_dwordx4 v112, s[40:43], s78 offen offset:0 lds
    buffer_load_dwordx4 v113, s[40:43], s78 offen offset:1024 lds
    buffer_load_dwordx4 v114, s[40:43], s78 offen offset:2048 lds
    buffer_load_dwordx4 v115, s[40:43], s78 offen offset:3072 lds
    s_waitcnt vmcnt(16)
    s_barrier
    s_add_u32 m0, s80, 32768
    s_add_u32 s77, s77, 128
    buffer_load_dwordx4 v108, s[36:39], s77 offen offset:0 lds
    buffer_load_dwordx4 v109, s[36:39], s77 offen offset:1024 lds
    buffer_load_dwordx4 v110, s[36:39], s77 offen offset:2048 lds
    buffer_load_dwordx4 v111, s[36:39], s77 offen offset:3072 lds
    s_add_u32 m0, s80, 49152
    s_add_u32 s78, s78, 221184
    buffer_load_dwordx4 v112, s[40:43], s78 offen offset:0 lds
    buffer_load_dwordx4 v113, s[40:43], s78 offen offset:1024 lds
    buffer_load_dwordx4 v114, s[40:43], s78 offen offset:2048 lds
    buffer_load_dwordx4 v115, s[40:43], s78 offen offset:3072 lds
    s_waitcnt vmcnt(16)
    s_barrier
    s_add_u32 m0, s80, 65536
    s_add_u32 s77, s77, 128
    buffer_load_dwordx4 v108, s[36:39], s77 offen offset:0 lds
    buffer_load_dwordx4 v109, s[36:39], s77 offen offset:1024 lds
    buffer_load_dwordx4 v110, s[36:39], s77 offen offset:2048 lds
    buffer_load_dwordx4 v111, s[36:39], s77 offen offset:3072 lds
    s_add_u32 m0, s80, 81920
    s_add_u32 s78, s78, 221184
    buffer_load_dwordx4 v112, s[40:43], s78 offen offset:0 lds
    buffer_load_dwordx4 v113, s[40:43], s78 offen offset:1024 lds
    buffer_load_dwordx4 v114, s[40:43], s78 offen offset:2048 lds
    buffer_load_dwordx4 v115, s[40:43], s78 offen offset:3072 lds
    s_waitcnt vmcnt(16)
    s_barrier
    s_add_u32 m0, s80, 98304
    s_add_u32 s77, s77, 128
    buffer_load_dwordx4 v108, s[36:39], s77 offen offset:0 lds
    buffer_load_dwordx4 v109, s[36:39], s77 offen offset:1024 lds
    buffer_load_dwordx4 v110, s[36:39], s77 offen offset:2048 lds
    buffer_load_dwordx4 v111, s[36:39], s77 offen offset:3072 lds
    s_add_u32 m0, s80, 114688
    s_add_u32 s78, s78, 221184
    buffer_load_dwordx4 v112, s[40:43], s78 offen offset:0 lds
    buffer_load_dwordx4 v113, s[40:43], s78 offen offset:1024 lds
    buffer_load_dwordx4 v114, s[40:43], s78 offen offset:2048 lds
    buffer_load_dwordx4 v115, s[40:43], s78 offen offset:3072 lds
    s_waitcnt vmcnt(16)
    s_barrier
    s_add_u32 m0, s80, 0
    s_add_u32 s77, s77, 128
    buffer_load_dwordx4 v108, s[36:39], s77 offen offset:0 lds
    buffer_load_dwordx4 v109, s[36:39], s77 offen offset:1024 lds
    buffer_load_dwordx4 v110, s[36:39], s77 offen offset:2048 lds
    buffer_load_dwordx4 v111, s[36:39], s77 offen offset:3072 lds
    s_add_u32 m0, s80, 16384
    s_add_u32 s78, s78, 221184
    buffer_load_dwordx4 v112, s[40:43], s78 offen offset:0 lds
    buffer_load_dwordx4 v113, s[40:43], s78 offen offset:1024 lds
    buffer_load_dwordx4 v114, s[40:43], s78 offen offset:2048 lds
    buffer_load_dwordx4 v115, s[40:43], s78 offen offset:3072 lds
    s_waitcnt vmcnt(16)
    s_barrier
    s_add_u32 m0, s80, 32768
    s_add_u32 s77, s77, 128
    buffer_load_dwordx4 v108, s[36:39], s77 offen offset:0 lds
    buffer_load_dwordx4 v109, s[36:39], s77 offen offset:1024 lds
    buffer_load_dwordx4 v110, s[36:39], s77 offen offset:2048 lds
    buffer_load_dwordx4 v111, s[36:39], s77 offen offset:3072 lds
    s_add_u32 m0, s80, 49152
    s_add_u32 s78, s78, 221184
    buffer_load_dwordx4 v112, s[40:43], s78 offen offset:0 lds
    buffer_load_dwordx4 v113, s[40:43], s78 offen offset:1024 lds
    buffer_load_dwordx4 v114, s[40:43], s78 offen offset:2048 lds
    buffer_load_dwordx4 v115, s[40:43], s78 offen offset:3072 lds
    s_waitcnt vmcnt(16)
    s_barrier
    s_mul_i32 s76, s60, 8192
    s_lshl_b32 s72, s3, 11
    s_add_u32 s76, s76, s72
    s_add_u32 s76, s76, 1048576
    buffer_load_dwordx4 v[72:75], v253, s[44:47], s76 offen offset:0 sc1
    buffer_load_dwordx4 v[76:79], v253, s[44:47], s76 offen offset:1024 sc1
    s_add_u32 s85, s85, 122880
    buffer_load_dwordx4 v[176:179], v253, s[44:47], s85 offen offset:2048 sc1
    buffer_load_dwordx4 v[180:183], v253, s[44:47], s85 offen offset:3072 sc1
    s_add_u32 s85, s85, 4096
    buffer_load_dwordx4 v[184:187], v253, s[44:47], s85 offen offset:0 sc1
    s_add_u32 s85, s85, 36864
    buffer_load_dwordx4 v[188:191], v253, s[44:47], s85 offen offset:0 sc1
    buffer_load_dwordx4 v[192:195], v253, s[44:47], s85 offen offset:1024 sc1
    buffer_load_dwordx4 v[196:199], v253, s[44:47], s85 offen offset:2048 sc1
    buffer_load_dwordx4 v[200:203], v253, s[44:47], s85 offen offset:3072 sc1
    s_add_u32 s85, s85, 4096
    buffer_load_dwordx4 v[204:207], v253, s[44:47], s85 offen offset:0 sc1
    s_add_u32 s85, s85, 36864
    buffer_load_dwordx4 v[208:211], v253, s[44:47], s85 offen offset:0 sc1
    buffer_load_dwordx4 v[212:215], v253, s[44:47], s85 offen offset:1024 sc1
    s_waitcnt vmcnt(20)
    s_barrier
    buffer_load_dwordx4 v[216:219], v253, s[44:47], s85 offen offset:2048 sc1
    buffer_load_dwordx4 v[220:223], v253, s[44:47], s85 offen offset:3072 sc1
    s_add_u32 s85, s85, 4096
    buffer_load_dwordx4 v[224:227], v253, s[44:47], s85 offen offset:0 sc1
    s_add_u32 s85, s85, 36864
    buffer_load_dwordx4 v[228:231], v254, s[44:47], s85 offen offset:0 sc1
    buffer_load_dwordx4 v[232:235], v254, s[44:47], s85 offen offset:1024 sc1
    buffer_load_dwordx4 v[236:239], v254, s[44:47], s85 offen offset:2048 sc1
    buffer_load_dwordx4 v[240:243], v254, s[44:47], s85 offen offset:3072 sc1
    s_add_u32 s85, s85, 4096
    buffer_load_dwordx4 v[244:247], v254, s[44:47], s85 offen offset:0 sc1
    s_add_u32 s85, s85, 4294717440
    buffer_load_dwordx4 v[108:111], v253, s[44:47], s85 offen offset:0 sc1
    buffer_load_dwordx4 v[112:115], v253, s[44:47], s85 offen offset:1024 sc1
    buffer_load_dwordx4 v[116:119], v253, s[44:47], s85 offen offset:2048 sc1
    s_waitcnt vmcnt(23)
    s_barrier
    buffer_load_dwordx4 v[120:123], v253, s[44:47], s85 offen offset:3072 sc1
    s_add_u32 s85, s85, 4096
    buffer_load_dwordx4 v[124:127], v253, s[44:47], s85 offen offset:0 sc1
    s_add_u32 s85, s85, 36864
    buffer_load_dwordx4 v[128:131], v253, s[44:47], s85 offen offset:0 sc1
    buffer_load_dwordx4 v[132:135], v253, s[44:47], s85 offen offset:1024 sc1
    buffer_load_dwordx4 v[136:139], v253, s[44:47], s85 offen offset:2048 sc1
    buffer_load_dwordx4 v[140:143], v253, s[44:47], s85 offen offset:3072 sc1
    s_add_u32 s85, s85, 4096
    buffer_load_dwordx4 v[144:147], v253, s[44:47], s85 offen offset:0 sc1
    s_add_u32 s85, s85, 36864
    buffer_load_dwordx4 v[148:151], v253, s[44:47], s85 offen offset:0 sc1
    buffer_load_dwordx4 v[152:155], v253, s[44:47], s85 offen offset:1024 sc1
    buffer_load_dwordx4 v[156:159], v253, s[44:47], s85 offen offset:2048 sc1
    buffer_load_dwordx4 v[160:163], v253, s[44:47], s85 offen offset:3072 sc1
    s_barrier
    s_add_u32 s85, s85, 4096
    buffer_load_dwordx4 v[164:167], v253, s[44:47], s85 offen offset:0 sc1
    ds_write_b32 v52, v58 offset:15840
    ds_write_b32 v52, v12 offset:16368
    ds_write_b32 v52, v13 offset:16896
    ds_write_b32 v52, v14 offset:0
    ds_write_b32 v52, v15 offset:4224
    ds_write_b32 v52, v15 offset:2112
    ds_write_b32 v52, v16 offset:17424
    ds_write_b32 v52, v17 offset:17952
    ds_write_b32 v52, v18 offset:528
    ds_write_b32 v52, v19 offset:2640
    ds_write_b32 v52, v20 offset:18480
    ds_write_b32 v52, v21 offset:19008
    ds_write_b32 v52, v22 offset:1056
    ds_write_b32 v52, v23 offset:3168
    ds_write_b32 v52, v24 offset:19536
    ds_write_b32 v52, v25 offset:20064
    ds_write_b32 v52, v26 offset:1584
    ds_write_b32 v52, v27 offset:3696
    ds_write_b32 v52, v28 offset:20592
    ds_write_b32 v52, v29 offset:21120
    ds_write_b32 v52, v30 offset:6336
    ds_write_b32 v52, v31 offset:21648
    ds_write_b32 v52, v32 offset:22176
    ds_write_b32 v52, v33 offset:4752
    ds_write_b32 v52, v34 offset:5808
    ds_write_b32 v52, v34 offset:6864
    ds_write_b32 v52, v35 offset:22704
    ds_write_b32 v52, v36 offset:23232
    ds_write_b32 v52, v37 offset:5280
    ds_write_b32 v52, v38 offset:7392
    ds_write_b32 v52, v39 offset:23760
    ds_write_b32 v52, v40 offset:24288
    ds_write_b32 v52, v41 offset:7920
    ds_write_b32 v52, v42 offset:24816
    ds_write_b32 v52, v43 offset:25344
    ds_write_b32 v52, v44 offset:8448
    ds_write_b32 v52, v45 offset:8976
    ds_write_b32 v52, v46 offset:25872
    ds_write_b32 v52, v47 offset:26400
    ds_write_b32 v52, v48 offset:9504
    ds_write_b32 v52, v49 offset:26928
    ds_write_b32 v52, v50 offset:27456
    ds_write_b32 v52, v51 offset:10560
    ds_write_b32 v52, v80 offset:11088
    ds_write_b32 v52, v81 offset:27984
    ds_write_b32 v52, v82 offset:28512
    ds_write_b32 v52, v83 offset:11616
    ds_write_b32 v52, v84 offset:29040
    ds_write_b32 v52, v85 offset:29568
    ds_write_b32 v52, v86 offset:10032
    ds_write_b32 v52, v87 offset:12672
    ds_write_b32 v52, v88 offset:30096
    ds_write_b32 v52, v89 offset:30624
    ds_write_b32 v52, v90 offset:12144
    ds_write_b32 v52, v91 offset:14256
    ds_write_b32 v52, v92 offset:31152
    ds_write_b32 v52, v93 offset:31680
    ds_write_b32 v52, v94 offset:13200
    ds_write_b32 v52, v95 offset:13728
    ds_write_b32 v52, v96 offset:32208
    ds_write_b32 v52, v97 offset:14784
    ds_write_b32 v52, v98 offset:15312
    s_waitcnt vmcnt(33)
    ds_write_b128 v1, v[72:75]
    ds_write_b128 v1, v[76:79] offset:512
    ds_write_b32 v2, v11
    s_lshl1_add_u32 s71, s60, s74
    s_mul_i32 s71, s71, 4096
    s_lshl_b32 s72, s75, 11
    s_add_u32 s71, s71, s72
    s_add_u32 s71, s71, 4194304
    s_waitcnt lgkmcnt(0)
    s_barrier
    ds_read_b128 v[32:35], v53 offset:0
    ds_read_b128 v[36:39], v54 offset:15840
    ds_read_b128 v[40:43], v53 offset:32
    ds_read_b128 v[44:47], v54 offset:15872
    ds_read_b128 v[76:79], v53 offset:64
    ds_read_b128 v[80:83], v54 offset:15904
    ds_read_b128 v[84:87], v53 offset:96
    ds_read_b128 v[88:91], v54 offset:15936
    ds_read_b128 v[92:95], v53 offset:128
    ds_read_b128 v[96:99], v54 offset:15968
    s_waitcnt lgkmcnt(8)
    v_mfma_f32_32x32x16_bf16 v[16:31], v[32:35], v[36:39], 0
    ds_read_b128 v[100:103], v53 offset:160
    ds_read_b128 v[104:107], v54 offset:16000
    s_waitcnt lgkmcnt(8)
    v_mfma_f32_32x32x16_bf16 v[16:31], v[40:43], v[44:47], v[16:31]
    ds_read_b128 v[32:35], v53 offset:192
    ds_read_b128 v[36:39], v54 offset:16032
    s_waitcnt lgkmcnt(8)
    v_mfma_f32_32x32x16_bf16 v[16:31], v[76:79], v[80:83], v[16:31]
    ds_read_b128 v[40:43], v53 offset:224
    ds_read_b128 v[44:47], v54 offset:16064
    s_waitcnt lgkmcnt(8)
    v_mfma_f32_32x32x16_bf16 v[16:31], v[84:87], v[88:91], v[16:31]
    ds_read_b128 v[76:79], v53 offset:256
    ds_read_b128 v[80:83], v54 offset:16096
    s_waitcnt lgkmcnt(8)
    v_mfma_f32_32x32x16_bf16 v[16:31], v[92:95], v[96:99], v[16:31]
    ds_read_b128 v[84:87], v53 offset:288
    ds_read_b128 v[88:91], v54 offset:16128
    s_waitcnt lgkmcnt(8)
    v_mfma_f32_32x32x16_bf16 v[16:31], v[100:103], v[104:107], v[16:31]
    ds_read_b128 v[92:95], v53 offset:320
    ds_read_b128 v[96:99], v54 offset:16160
    s_waitcnt lgkmcnt(8)
    v_mfma_f32_32x32x16_bf16 v[16:31], v[32:35], v[36:39], v[16:31]
    ds_read_b128 v[100:103], v53 offset:352
    ds_read_b128 v[104:107], v54 offset:16192
    s_waitcnt lgkmcnt(8)
    v_mfma_f32_32x32x16_bf16 v[16:31], v[40:43], v[44:47], v[16:31]
    ds_read_b128 v[32:35], v53 offset:384
    ds_read_b128 v[36:39], v54 offset:16224
    s_waitcnt lgkmcnt(8)
    v_mfma_f32_32x32x16_bf16 v[16:31], v[76:79], v[80:83], v[16:31]
    ds_read_b128 v[40:43], v53 offset:416
    ds_read_b128 v[44:47], v54 offset:16256
    s_waitcnt lgkmcnt(8)
    v_mfma_f32_32x32x16_bf16 v[16:31], v[84:87], v[88:91], v[16:31]
    ds_read_b128 v[76:79], v53 offset:448
    ds_read_b128 v[80:83], v54 offset:16288
    s_waitcnt lgkmcnt(8)
    v_mfma_f32_32x32x16_bf16 v[16:31], v[92:95], v[96:99], v[16:31]
    ds_read_b128 v[84:87], v53 offset:480
    ds_read_b128 v[88:91], v54 offset:16320
    s_waitcnt lgkmcnt(8)
    v_mfma_f32_32x32x16_bf16 v[16:31], v[100:103], v[104:107], v[16:31]
    v_cmp_eq_u32 vcc, 0, v0
    s_mov_b32 s68, 0xaaaaaaaa
    s_mov_b32 s69, s68
    v_cndmask_b32 v69, 0, v69, vcc
    s_waitcnt lgkmcnt(6)
    v_mfma_f32_32x32x16_bf16 v[16:31], v[32:35], v[36:39], v[16:31]
    s_waitcnt lgkmcnt(4)
    v_mfma_f32_32x32x16_bf16 v[16:31], v[40:43], v[44:47], v[16:31]
    s_waitcnt lgkmcnt(2)
    v_mfma_f32_32x32x16_bf16 v[16:31], v[76:79], v[80:83], v[16:31]
    s_waitcnt lgkmcnt(0)
    v_mfma_f32_32x32x16_bf16 v[16:31], v[84:87], v[88:91], v[16:31]
    s_bitcmp1_b32 s3, 0
    s_nop 10
    v_add_f32 v16, v16, v69
    v_mov_b32 v34, 0
    v_cndmask_b32 v32, v27, v28, s[68:69]
    v_cndmask_b32 v33, v29, v30, s[68:69]
    s_cbranch_scc1 gated_mix__ssm_conv_s4d__mixer_channel_mlp__prompt_kernel_ke1
    v_cvt_pk_bf16_f32 v36, v19, v18
    v_cvt_pk_bf16_f32 v37, v17, v16
    v_cvt_pk_bf16_f32 v38, v23, v22
    v_cvt_pk_bf16_f32 v39, v21, v21
    v_cvt_pk_bf16_f32 v40, v26, v26
    v_cvt_pk_bf16_f32 v41, v25, v25
    v_cvt_pk_bf16_f32 v42, v25, v24
    v_cvt_pk_bf16_f32 v43, v24, v24
    v_cvt_pk_bf16_f32 v44, v28, v28
    v_cvt_pk_bf16_f32 v45, v28, v32
    v_cvt_pk_bf16_f32 v46, v27, v27
    v_cvt_pk_bf16_f32 v47, v27, v27
    v_cvt_pk_bf16_f32 v48, v30, v30
    v_cvt_pk_bf16_f32 v49, v30, v33
    v_cvt_pk_bf16_f32 v50, v29, v29
    v_cvt_pk_bf16_f32 v51, v29, v29
    s_branch gated_mix__ssm_conv_s4d__mixer_channel_mlp__prompt_kernel_kj2
gated_mix__ssm_conv_s4d__mixer_channel_mlp__prompt_kernel_ke1:
    v_cvt_pk_bf16_f32 v36, v20, v19
    v_cvt_pk_bf16_f32 v37, v18, v17
    v_cvt_pk_bf16_f32 v38, v23, v23
    v_cvt_pk_bf16_f32 v39, v22, v21
    v_cvt_pk_bf16_f32 v40, v26, v26
    v_cvt_pk_bf16_f32 v41, v26, v25
    v_cvt_pk_bf16_f32 v42, v25, v25
    v_cvt_pk_bf16_f32 v43, v24, v24
    v_cvt_pk_bf16_f32 v44, v28, v28
    v_cvt_pk_bf16_f32 v45, v28, v28
    v_cvt_pk_bf16_f32 v46, v32, v27
    v_cvt_pk_bf16_f32 v47, v27, v27
    v_cvt_pk_bf16_f32 v48, v30, v30
    v_cvt_pk_bf16_f32 v49, v30, v30
    v_cvt_pk_bf16_f32 v50, v33, v29
    v_cvt_pk_bf16_f32 v51, v29, v29
    v_cvt_pk_bf16_f32 v34, v16, v34
    v_cndmask_b32 v34, 0, v34, vcc
gated_mix__ssm_conv_s4d__mixer_channel_mlp__prompt_kernel_kj2:
    ds_write_b64 v55, v[36:37] offset:512
    ds_write_b64 v55, v[38:39]
    ds_write_b128 v56, v[40:43] offset:2048
    ds_write_b128 v56, v[44:47] offset:1024
    ds_write_b128 v56, v[48:51]
    s_mov_b64 exec, 0xff
    ds_write_b32 v57, v34 offset:4096
    s_mov_b64 exec, -1
gated_mix__ssm_conv_s4d__mixer_channel_mlp__prompt_kernel_hc:
    s_add_u32 s85, s85, 36864
    buffer_load_dwordx4 v[168:171], v253, s[44:47], s85 offen offset:0 sc1
    buffer_load_dwordx4 v[172:175], v253, s[44:47], s85 offen offset:1024 sc1
    s_waitcnt lgkmcnt(0)
    s_barrier
    ds_read_b128 v[104:107], v3 offset:3776
    ds_read2_b32 v[44:45], v4 offset0:176 offset1:177
    ds_read2_b32 v[46:47], v4 offset0:178 offset1:179
    ds_read_b128 v[100:103], v3 offset:3264
    ds_read_b128 v[96:99], v3 offset:2752
    ds_read_b128 v[92:95], v3 offset:2240
    ds_read_b128 v[88:91], v3 offset:1728
    ds_read_b128 v[84:87], v3 offset:1216
    ds_read_b128 v[80:83], v3 offset:704
    ds_read_b128 v[76:79], v3 offset:192
    s_waitcnt lgkmcnt(7)
    v_mfma_f32_16x16x32_bf16 v[40:43], v[44:47], v[104:107], 0
    ds_read_b128 v[104:107], v3 offset:3712
    s_waitcnt lgkmcnt(7)
    v_mfma_f32_16x16x32_bf16 v[36:39], v[44:47], v[100:103], 0
    ds_read2_b32 v[48:49], v4 offset0:48 offset1:49
    s_waitcnt lgkmcnt(7)
    v_mfma_f32_16x16x32_bf16 v[32:35], v[44:47], v[96:99], 0
    ds_read2_b32 v[50:51], v4 offset0:50 offset1:51
    s_waitcnt lgkmcnt(7)
    v_mfma_f32_16x16x32_bf16 v[28:31], v[44:47], v[92:95], 0
    ds_read2_b32 v[52:53], v5 offset0:176 offset1:177
    s_waitcnt lgkmcnt(7)
    v_mfma_f32_16x16x32_bf16 v[24:27], v[44:47], v[88:91], 0
    ds_read2_b32 v[54:55], v5 offset0:178 offset1:179
    s_waitcnt lgkmcnt(7)
    v_mfma_f32_16x16x32_bf16 v[20:23], v[44:47], v[84:87], 0
    ds_read2_b32 v[56:57], v5 offset0:48 offset1:49
    s_waitcnt lgkmcnt(7)
    v_mfma_f32_16x16x32_bf16 v[16:19], v[44:47], v[80:83], 0
    ds_read2_b32 v[58:59], v5 offset0:50 offset1:51
    s_waitcnt lgkmcnt(7)
    v_mfma_f32_16x16x32_bf16 v[12:15], v[44:47], v[76:79], 0
    ds_read2_b32 v[60:61], v6 offset0:176 offset1:177
    s_waitcnt lgkmcnt(5)
    v_mfma_f32_16x16x32_bf16 v[40:43], v[48:51], v[100:103], v[40:43]
    ds_read_b128 v[100:103], v3 offset:3200
    v_mfma_f32_16x16x32_bf16 v[36:39], v[48:51], v[96:99], v[36:39]
    ds_read2_b32 v[62:63], v6 offset0:178 offset1:179
    v_mfma_f32_16x16x32_bf16 v[32:35], v[48:51], v[92:95], v[32:35]
    ds_read2_b32 v[64:65], v6 offset0:48 offset1:49
    v_mfma_f32_16x16x32_bf16 v[28:31], v[48:51], v[88:91], v[28:31]
    ds_read2_b32 v[66:67], v6 offset0:50 offset1:51
    v_mfma_f32_16x16x32_bf16 v[24:27], v[48:51], v[84:87], v[24:27]
    ds_read2_b32 v[68:69], v7 offset0:176 offset1:177
    v_mfma_f32_16x16x32_bf16 v[20:23], v[48:51], v[80:83], v[20:23]
    ds_read2_b32 v[70:71], v7 offset0:178 offset1:179
    v_mfma_f32_16x16x32_bf16 v[16:19], v[48:51], v[76:79], v[16:19]
    ds_read2_b32 v[72:73], v7 offset0:48 offset1:49
    s_waitcnt lgkmcnt(10)
    v_mfma_f32_16x16x32_bf16 v[40:43], v[52:55], v[96:99], v[40:43]
    ds_read_b128 v[96:99], v3 offset:2688
    v_mfma_f32_16x16x32_bf16 v[36:39], v[52:55], v[92:95], v[36:39]
    ds_read2_b32 v[74:75], v7 offset0:50 offset1:51
    v_mfma_f32_16x16x32_bf16 v[32:35], v[52:55], v[88:91], v[32:35]
    ds_read2_b32 v[44:45], v4 offset0:160 offset1:161
    v_mfma_f32_16x16x32_bf16 v[28:31], v[52:55], v[84:87], v[28:31]
    ds_read2_b32 v[46:47], v4 offset0:162 offset1:163
    v_mfma_f32_16x16x32_bf16 v[24:27], v[52:55], v[80:83], v[24:27]
    ds_read2_b32 v[48:49], v4 offset0:32 offset1:33
    v_mfma_f32_16x16x32_bf16 v[20:23], v[52:55], v[76:79], v[20:23]
    ds_read2_b32 v[50:51], v4 offset0:34 offset1:35
    s_waitcnt lgkmcnt(14)
    v_mfma_f32_16x16x32_bf16 v[40:43], v[56:59], v[92:95], v[40:43]
    ds_read_b128 v[92:95], v3 offset:2176
    v_mfma_f32_16x16x32_bf16 v[36:39], v[56:59], v[88:91], v[36:39]
    ds_read2_b32 v[52:53], v5 offset0:160 offset1:161
    v_mfma_f32_16x16x32_bf16 v[32:35], v[56:59], v[84:87], v[32:35]
    ds_read2_b32 v[54:55], v5 offset0:162 offset1:163
    v_mfma_f32_16x16x32_bf16 v[28:31], v[56:59], v[80:83], v[28:31]
    v_mfma_f32_16x16x32_bf16 v[24:27], v[56:59], v[76:79], v[24:27]
    ds_read2_b32 v[56:57], v5 offset0:32 offset1:33
    s_waitcnt lgkmcnt(15)
    v_mfma_f32_16x16x32_bf16 v[40:43], v[60:63], v[88:91], v[40:43]
    ds_read_b128 v[88:91], v3 offset:1664
    v_mfma_f32_16x16x32_bf16 v[36:39], v[60:63], v[84:87], v[36:39]
    ds_read2_b32 v[58:59], v5 offset0:34 offset1:35
    v_mfma_f32_16x16x32_bf16 v[32:35], v[60:63], v[80:83], v[32:35]
    v_mfma_f32_16x16x32_bf16 v[28:31], v[60:63], v[76:79], v[28:31]
    ds_read2_b32 v[60:61], v6 offset0:160 offset1:161
    s_waitcnt lgkmcnt(15)
    v_mfma_f32_16x16x32_bf16 v[40:43], v[64:67], v[84:87], v[40:43]
    ds_read_b128 v[84:87], v3 offset:1152
    v_mfma_f32_16x16x32_bf16 v[36:39], v[64:67], v[80:83], v[36:39]
    ds_read2_b32 v[62:63], v6 offset0:162 offset1:163
    v_mfma_f32_16x16x32_bf16 v[32:35], v[64:67], v[76:79], v[32:35]
    ds_read2_b32 v[64:65], v6 offset0:32 offset1:33
    s_waitcnt lgkmcnt(15)
    v_mfma_f32_16x16x32_bf16 v[40:43], v[68:71], v[80:83], v[40:43]
    ds_read_b128 v[80:83], v3 offset:640
    v_mfma_f32_16x16x32_bf16 v[36:39], v[68:71], v[76:79], v[36:39]
    ds_read2_b32 v[66:67], v6 offset0:34 offset1:35
    s_waitcnt lgkmcnt(15)
    v_mfma_f32_16x16x32_bf16 v[40:43], v[72:75], v[76:79], v[40:43]
    ds_read_b128 v[76:79], v3 offset:128
    s_waitcnt lgkmcnt(15)
    v_mfma_f32_16x16x32_bf16 v[40:43], v[44:47], v[104:107], v[40:43]
    ds_read_b128 v[104:107], v3 offset:3648
    v_mfma_f32_16x16x32_bf16 v[36:39], v[44:47], v[100:103], v[36:39]
    ds_read2_b32 v[68:69], v7 offset0:160 offset1:161
    v_mfma_f32_16x16x32_bf16 v[32:35], v[44:47], v[96:99], v[32:35]
    ds_read2_b32 v[70:71], v7 offset0:162 offset1:163
    s_waitcnt lgkmcnt(15)
    v_mfma_f32_16x16x32_bf16 v[28:31], v[44:47], v[92:95], v[28:31]
    ds_read2_b32 v[72:73], v7 offset0:32 offset1:33
    s_waitcnt lgkmcnt(12)
    v_mfma_f32_16x16x32_bf16 v[24:27], v[44:47], v[88:91], v[24:27]
    ds_read2_b32 v[74:75], v7 offset0:34 offset1:35
    s_waitcnt lgkmcnt(10)
    v_mfma_f32_16x16x32_bf16 v[20:23], v[44:47], v[84:87], v[20:23]
    s_waitcnt lgkmcnt(7)
    v_mfma_f32_16x16x32_bf16 v[16:19], v[44:47], v[80:83], v[16:19]
    s_waitcnt lgkmcnt(5)
    v_mfma_f32_16x16x32_bf16 v[12:15], v[44:47], v[76:79], v[12:15]
    ds_read2_b32 v[44:45], v4 offset0:144 offset1:145
    v_mfma_f32_16x16x32_bf16 v[40:43], v[48:51], v[100:103], v[40:43]
    ds_read_b128 v[100:103], v3 offset:3136
    v_mfma_f32_16x16x32_bf16 v[36:39], v[48:51], v[96:99], v[36:39]
    ds_read2_b32 v[46:47], v4 offset0:146 offset1:147
    v_mfma_f32_16x16x32_bf16 v[32:35], v[48:51], v[92:95], v[32:35]
    v_mfma_f32_16x16x32_bf16 v[28:31], v[48:51], v[88:91], v[28:31]
    v_mfma_f32_16x16x32_bf16 v[24:27], v[48:51], v[84:87], v[24:27]
    v_mfma_f32_16x16x32_bf16 v[20:23], v[48:51], v[80:83], v[20:23]
    v_mfma_f32_16x16x32_bf16 v[16:19], v[48:51], v[76:79], v[16:19]
    ds_read2_b32 v[48:49], v4 offset0:16 offset1:17
    v_mfma_f32_16x16x32_bf16 v[40:43], v[52:55], v[96:99], v[40:43]
    ds_read_b128 v[96:99], v3 offset:2624
    v_mfma_f32_16x16x32_bf16 v[36:39], v[52:55], v[92:95], v[36:39]
    ds_read2_b32 v[50:51], v4 offset0:18 offset1:19
    v_mfma_f32_16x16x32_bf16 v[32:35], v[52:55], v[88:91], v[32:35]
    v_mfma_f32_16x16x32_bf16 v[28:31], v[52:55], v[84:87], v[28:31]
    v_mfma_f32_16x16x32_bf16 v[24:27], v[52:55], v[80:83], v[24:27]
    v_mfma_f32_16x16x32_bf16 v[20:23], v[52:55], v[76:79], v[20:23]
    ds_read2_b32 v[52:53], v5 offset0:144 offset1:145
    v_mfma_f32_16x16x32_bf16 v[40:43], v[56:59], v[92:95], v[40:43]
    ds_read_b128 v[92:95], v3 offset:2112
    v_mfma_f32_16x16x32_bf16 v[36:39], v[56:59], v[88:91], v[36:39]
    ds_read2_b32 v[54:55], v5 offset0:146 offset1:147
    v_mfma_f32_16x16x32_bf16 v[32:35], v[56:59], v[84:87], v[32:35]
    v_mfma_f32_16x16x32_bf16 v[28:31], v[56:59], v[80:83], v[28:31]
    v_mfma_f32_16x16x32_bf16 v[24:27], v[56:59], v[76:79], v[24:27]
    ds_read2_b32 v[56:57], v5 offset0:16 offset1:17
    v_mfma_f32_16x16x32_bf16 v[40:43], v[60:63], v[88:91], v[40:43]
    ds_read_b128 v[88:91], v3 offset:1600
    v_mfma_f32_16x16x32_bf16 v[36:39], v[60:63], v[84:87], v[36:39]
    ds_read2_b32 v[58:59], v5 offset0:18 offset1:19
    v_mfma_f32_16x16x32_bf16 v[32:35], v[60:63], v[80:83], v[32:35]
    v_mfma_f32_16x16x32_bf16 v[28:31], v[60:63], v[76:79], v[28:31]
    ds_read2_b32 v[60:61], v6 offset0:144 offset1:145
    v_mfma_f32_16x16x32_bf16 v[40:43], v[64:67], v[84:87], v[40:43]
    ds_read_b128 v[84:87], v3 offset:1088
    v_mfma_f32_16x16x32_bf16 v[36:39], v[64:67], v[80:83], v[36:39]
    ds_read2_b32 v[62:63], v6 offset0:146 offset1:147
    v_mfma_f32_16x16x32_bf16 v[32:35], v[64:67], v[76:79], v[32:35]
    ds_read2_b32 v[64:65], v6 offset0:16 offset1:17
    s_waitcnt lgkmcnt(15)
    v_mfma_f32_16x16x32_bf16 v[40:43], v[68:71], v[80:83], v[40:43]
    ds_read_b128 v[80:83], v3 offset:576
    v_mfma_f32_16x16x32_bf16 v[36:39], v[68:71], v[76:79], v[36:39]
    ds_read2_b32 v[66:67], v6 offset0:18 offset1:19
    v_mfma_f32_16x16x32_bf16 v[40:43], v[72:75], v[76:79], v[40:43]
    ds_read_b128 v[76:79], v3 offset:64
    s_waitcnt lgkmcnt(15)
    v_mfma_f32_16x16x32_bf16 v[40:43], v[44:47], v[104:107], v[40:43]
    ds_read_b128 v[104:107], v3 offset:3584
    v_mfma_f32_16x16x32_bf16 v[36:39], v[44:47], v[100:103], v[36:39]
    ds_read2_b32 v[68:69], v7 offset0:144 offset1:145
    s_waitcnt lgkmcnt(15)
    v_mfma_f32_16x16x32_bf16 v[32:35], v[44:47], v[96:99], v[32:35]
    ds_read2_b32 v[70:71], v7 offset0:146 offset1:147
    s_waitcnt lgkmcnt(14)
    v_mfma_f32_16x16x32_bf16 v[28:31], v[44:47], v[92:95], v[28:31]
    ds_read2_b32 v[72:73], v7 offset0:16 offset1:17
    s_waitcnt lgkmcnt(12)
    v_mfma_f32_16x16x32_bf16 v[24:27], v[44:47], v[88:91], v[24:27]
    ds_read2_b32 v[74:75], v7 offset0:18 offset1:19
    s_waitcnt lgkmcnt(10)
    v_mfma_f32_16x16x32_bf16 v[20:23], v[44:47], v[84:87], v[20:23]
    s_waitcnt lgkmcnt(7)
    v_mfma_f32_16x16x32_bf16 v[16:19], v[44:47], v[80:83], v[16:19]
    s_waitcnt lgkmcnt(5)
    v_mfma_f32_16x16x32_bf16 v[12:15], v[44:47], v[76:79], v[12:15]
    ds_read2_b32 v[44:45], v4 offset0:128 offset1:129
    v_mfma_f32_16x16x32_bf16 v[40:43], v[48:51], v[100:103], v[40:43]
    ds_read_b128 v[100:103], v3 offset:3072
    v_mfma_f32_16x16x32_bf16 v[36:39], v[48:51], v[96:99], v[36:39]
    ds_read2_b32 v[46:47], v4 offset0:130 offset1:131
    v_mfma_f32_16x16x32_bf16 v[32:35], v[48:51], v[92:95], v[32:35]
    v_mfma_f32_16x16x32_bf16 v[28:31], v[48:51], v[88:91], v[28:31]
    v_mfma_f32_16x16x32_bf16 v[24:27], v[48:51], v[84:87], v[24:27]
    v_mfma_f32_16x16x32_bf16 v[20:23], v[48:51], v[80:83], v[20:23]
    v_mfma_f32_16x16x32_bf16 v[16:19], v[48:51], v[76:79], v[16:19]
    ds_read2_b32 v[48:49], v4 offset0:0 offset1:1
    v_mfma_f32_16x16x32_bf16 v[40:43], v[52:55], v[96:99], v[40:43]
    ds_read_b128 v[96:99], v3 offset:2560
    v_mfma_f32_16x16x32_bf16 v[36:39], v[52:55], v[92:95], v[36:39]
    ds_read2_b32 v[50:51], v4 offset0:2 offset1:3
    v_mfma_f32_16x16x32_bf16 v[32:35], v[52:55], v[88:91], v[32:35]
    v_mfma_f32_16x16x32_bf16 v[28:31], v[52:55], v[84:87], v[28:31]
    v_mfma_f32_16x16x32_bf16 v[24:27], v[52:55], v[80:83], v[24:27]
    v_mfma_f32_16x16x32_bf16 v[20:23], v[52:55], v[76:79], v[20:23]
    ds_read2_b32 v[52:53], v5 offset0:128 offset1:129
    v_mfma_f32_16x16x32_bf16 v[40:43], v[56:59], v[92:95], v[40:43]
    ds_read_b128 v[92:95], v3 offset:2048
    v_mfma_f32_16x16x32_bf16 v[36:39], v[56:59], v[88:91], v[36:39]
    ds_read2_b32 v[54:55], v5 offset0:130 offset1:131
    v_mfma_f32_16x16x32_bf16 v[32:35], v[56:59], v[84:87], v[32:35]
    v_mfma_f32_16x16x32_bf16 v[28:31], v[56:59], v[80:83], v[28:31]
    v_mfma_f32_16x16x32_bf16 v[24:27], v[56:59], v[76:79], v[24:27]
    ds_read2_b32 v[56:57], v5 offset0:0 offset1:1
    v_mfma_f32_16x16x32_bf16 v[40:43], v[60:63], v[88:91], v[40:43]
    ds_read_b128 v[88:91], v3 offset:1536
    v_mfma_f32_16x16x32_bf16 v[36:39], v[60:63], v[84:87], v[36:39]
    ds_read2_b32 v[58:59], v5 offset0:2 offset1:3
    v_mfma_f32_16x16x32_bf16 v[32:35], v[60:63], v[80:83], v[32:35]
    v_mfma_f32_16x16x32_bf16 v[28:31], v[60:63], v[76:79], v[28:31]
    ds_read2_b32 v[60:61], v6 offset0:128 offset1:129
    v_mfma_f32_16x16x32_bf16 v[40:43], v[64:67], v[84:87], v[40:43]
    ds_read_b128 v[84:87], v3 offset:1024
    v_mfma_f32_16x16x32_bf16 v[36:39], v[64:67], v[80:83], v[36:39]
    ds_read2_b32 v[62:63], v6 offset0:130 offset1:131
    v_mfma_f32_16x16x32_bf16 v[32:35], v[64:67], v[76:79], v[32:35]
    ds_read2_b32 v[64:65], v6 offset0:0 offset1:1
    s_waitcnt lgkmcnt(15)
    v_mfma_f32_16x16x32_bf16 v[40:43], v[68:71], v[80:83], v[40:43]
    ds_read_b128 v[80:83], v3 offset:512
    v_mfma_f32_16x16x32_bf16 v[36:39], v[68:71], v[76:79], v[36:39]
    ds_read2_b32 v[66:67], v6 offset0:2 offset1:3
    v_mfma_f32_16x16x32_bf16 v[40:43], v[72:75], v[76:79], v[40:43]
    ds_read_b128 v[76:79], v3 offset:0
    s_waitcnt lgkmcnt(15)
    v_mfma_f32_16x16x32_bf16 v[40:43], v[44:47], v[104:107], v[40:43]
    ds_read2_b32 v[68:69], v7 offset0:128 offset1:129
    v_mfma_f32_16x16x32_bf16 v[36:39], v[44:47], v[100:103], v[36:39]
    ds_read2_b32 v[70:71], v7 offset0:130 offset1:131
    s_waitcnt lgkmcnt(15)
    v_mfma_f32_16x16x32_bf16 v[32:35], v[44:47], v[96:99], v[32:35]
    ds_read2_b32 v[72:73], v7 offset0:0 offset1:1
    s_waitcnt lgkmcnt(14)
    v_mfma_f32_16x16x32_bf16 v[28:31], v[44:47], v[92:95], v[28:31]
    ds_read2_b32 v[74:75], v7 offset0:2 offset1:3
    s_waitcnt lgkmcnt(12)
    v_mfma_f32_16x16x32_bf16 v[24:27], v[44:47], v[88:91], v[24:27]
    s_waitcnt lgkmcnt(9)
    v_mfma_f32_16x16x32_bf16 v[20:23], v[44:47], v[84:87], v[20:23]
    s_waitcnt lgkmcnt(6)
    v_mfma_f32_16x16x32_bf16 v[16:19], v[44:47], v[80:83], v[16:19]
    s_waitcnt lgkmcnt(4)
    v_mfma_f32_16x16x32_bf16 v[12:15], v[44:47], v[76:79], v[12:15]
    v_mfma_f32_16x16x32_bf16 v[40:43], v[48:51], v[100:103], v[40:43]
    v_mfma_f32_16x16x32_bf16 v[36:39], v[48:51], v[96:99], v[36:39]
    v_mfma_f32_16x16x32_bf16 v[32:35], v[48:51], v[92:95], v[32:35]
    v_mfma_f32_16x16x32_bf16 v[28:31], v[48:51], v[88:91], v[28:31]
    v_mfma_f32_16x16x32_bf16 v[24:27], v[48:51], v[84:87], v[24:27]
    v_mfma_f32_16x16x32_bf16 v[20:23], v[48:51], v[80:83], v[20:23]
    v_mfma_f32_16x16x32_bf16 v[16:19], v[48:51], v[76:79], v[16:19]
    v_mfma_f32_16x16x32_bf16 v[40:43], v[52:55], v[96:99], v[40:43]
    v_mfma_f32_16x16x32_bf16 v[36:39], v[52:55], v[92:95], v[36:39]
    v_mfma_f32_16x16x32_bf16 v[32:35], v[52:55], v[88:91], v[32:35]
    v_mfma_f32_16x16x32_bf16 v[28:31], v[52:55], v[84:87], v[28:31]
    v_mfma_f32_16x16x32_bf16 v[24:27], v[52:55], v[80:83], v[24:27]
    v_mfma_f32_16x16x32_bf16 v[20:23], v[52:55], v[76:79], v[20:23]
    v_mfma_f32_16x16x32_bf16 v[40:43], v[56:59], v[92:95], v[40:43]
    v_mfma_f32_16x16x32_bf16 v[36:39], v[56:59], v[88:91], v[36:39]
    v_mfma_f32_16x16x32_bf16 v[32:35], v[56:59], v[84:87], v[32:35]
    v_mfma_f32_16x16x32_bf16 v[28:31], v[56:59], v[80:83], v[28:31]
    v_mfma_f32_16x16x32_bf16 v[24:27], v[56:59], v[76:79], v[24:27]
    v_mfma_f32_16x16x32_bf16 v[40:43], v[60:63], v[88:91], v[40:43]
    v_mfma_f32_16x16x32_bf16 v[36:39], v[60:63], v[84:87], v[36:39]
    v_mfma_f32_16x16x32_bf16 v[32:35], v[60:63], v[80:83], v[32:35]
    v_mfma_f32_16x16x32_bf16 v[28:31], v[60:63], v[76:79], v[28:31]
    v_mfma_f32_16x16x32_bf16 v[40:43], v[64:67], v[84:87], v[40:43]
    v_mfma_f32_16x16x32_bf16 v[36:39], v[64:67], v[80:83], v[36:39]
    v_mfma_f32_16x16x32_bf16 v[32:35], v[64:67], v[76:79], v[32:35]
    s_waitcnt lgkmcnt(2)
    v_mfma_f32_16x16x32_bf16 v[40:43], v[68:71], v[80:83], v[40:43]
    v_mfma_f32_16x16x32_bf16 v[36:39], v[68:71], v[76:79], v[36:39]
    s_waitcnt lgkmcnt(0)
    v_mfma_f32_16x16x32_bf16 v[40:43], v[72:75], v[76:79], v[40:43]
    s_cmp_eq_u32 s75, 0
    s_nop 6
    s_cbranch_scc1 gated_mix__ssm_conv_s4d__mixer_channel_mlp__prompt_kernel_cx3
    ds_write_b128 v9, v[12:15] offset:0
    ds_write_b128 v9, v[16:19] offset:1024
    ds_write_b128 v9, v[20:23] offset:2048
    ds_write_b128 v9, v[24:27] offset:3072
    s_branch gated_mix__ssm_conv_s4d__mixer_channel_mlp__prompt_kernel_cy4
gated_mix__ssm_conv_s4d__mixer_channel_mlp__prompt_kernel_cx3:
    ds_write_b128 v9, v[28:31] offset:0
    ds_write_b128 v9, v[32:35] offset:1024
    ds_write_b128 v9, v[36:39] offset:2048
    ds_write_b128 v9, v[40:43] offset:3072
gated_mix__ssm_conv_s4d__mixer_channel_mlp__prompt_kernel_cy4:
    s_waitcnt lgkmcnt(0)
    s_barrier
    s_cmp_eq_u32 s75, 0
    s_cbranch_scc1 gated_mix__ssm_conv_s4d__mixer_channel_mlp__prompt_kernel_cx5
    ds_read_b128 v[12:15], v10 offset:0
    ds_read_b128 v[16:19], v10 offset:1024
    ds_read_b128 v[20:23], v10 offset:2048
    ds_read_b128 v[24:27], v10 offset:3072
    s_branch gated_mix__ssm_conv_s4d__mixer_channel_mlp__prompt_kernel_cy6
gated_mix__ssm_conv_s4d__mixer_channel_mlp__prompt_kernel_cx5:
    ds_read_b128 v[28:31], v10 offset:0
    ds_read_b128 v[32:35], v10 offset:1024
    ds_read_b128 v[36:39], v10 offset:2048
    ds_read_b128 v[40:43], v10 offset:3072
gated_mix__ssm_conv_s4d__mixer_channel_mlp__prompt_kernel_cy6:
    s_lshl2_add_u32 s97, s56, s3
    s_mul_i32 s98, s97, 4
    s_add_u32 s98, s98, 768
    s_lshl_b32 s98, s98, 8
    v_cmp_gt_u32 s[90:91], 4, v0
    v_mov_b32 v252, 1073741824
    v_lshlrev_b32 v251, 8, v0
    v_cndmask_b32 v251, v252, v251, s[90:91]
    v_mov_b32 v252, 1
    s_waitcnt lgkmcnt(2)
    v_pk_add_f32 v[12:13], v[12:13], v[28:29]
    v_pk_add_f32 v[14:15], v[14:15], v[30:31]
    v_pk_add_f32 v[16:17], v[16:17], v[32:33]
    v_pk_add_f32 v[18:19], v[18:19], v[34:35]
    v_cvt_pk_bf16_f32 v44, v12, v13
    v_cvt_pk_bf16_f32 v45, v14, v15
    v_cvt_pk_bf16_f32 v46, v16, v17
    v_cvt_pk_bf16_f32 v47, v18, v19
    buffer_store_dwordx4 v[44:47], v8, s[44:47], s71 offen offset:0 sc1
    s_waitcnt lgkmcnt(0)
    v_pk_add_f32 v[20:21], v[20:21], v[36:37]
    v_pk_add_f32 v[22:23], v[22:23], v[38:39]
    v_pk_add_f32 v[24:25], v[24:25], v[40:41]
    v_pk_add_f32 v[26:27], v[26:27], v[42:43]
    v_cvt_pk_bf16_f32 v48, v20, v21
    v_cvt_pk_bf16_f32 v49, v22, v23
    v_cvt_pk_bf16_f32 v50, v24, v25
    v_cvt_pk_bf16_f32 v51, v26, v27
    buffer_store_dwordx4 v[48:51], v8, s[44:47], s71 offen offset:1024 sc1
    s_nop 1
    v_and_b32 v50, 15, v0
    s_lshl2_add_u32 s68, s61, s3
    s_lshl_b32 s69, s68, 9
    s_add_u32 s69, s69, 65536
    v_lshlrev_b32 v1, 5, v50
    buffer_load_dword v1, v1, s[44:47], s69 offen offset:28 sc1
    v_and_b32 v47, 48, v0
    s_mul_i32 s79, s62, 160
    s_mul_i32 s69, s3, 5120
    s_add_u32 s69, s69, 16384
    v_add_u32 v2, s69, v253
    v_mul_u32_u24 v45, 1280, v50
    v_lshrrev_b32 v46, 1, v47
    v_add_u32 v46, v45, v46
    v_add_u32 v45, v45, v47
    s_mul_i32 s87, s68, 20480
    s_add_u32 s87, s87, s79
    s_mul_i32 s69, s3, 15360
    s_add_u32 s69, s69, 62464
    v_add_u32 v47, s69, v253
    v_add_u32 v48, 102400, v2
    s_cmp_ge_u32 s57, 0
    s_cbranch_scc1 gated_mix__ssm_conv_s4d__mixer_channel_mlp__prompt_kernel_sa
    s_waitcnt vmcnt(0)
    buffer_atomic_add v252, v251, s[44:47], s98 offen sc1
gated_mix__ssm_conv_s4d__mixer_channel_mlp__prompt_kernel_sa:
    s_barrier
    s_cmp_ge_u32 s57, 0
    s_cbranch_scc0 gated_mix__ssm_conv_s4d__mixer_channel_mlp__prompt_kernel_sb
    s_waitcnt vmcnt(0)
    buffer_atomic_add v252, v251, s[44:47], s98 offen sc1
gated_mix__ssm_conv_s4d__mixer_channel_mlp__prompt_kernel_sb:
    s_add_u32 s86, s3, 1
    s_and_b32 s86, s86, 3
    s_lshl2_add_u32 s86, s61, s86
    s_mul_i32 s86, s86, 54
    s_add_u32 s86, s86, s101
    s_lshl_b32 s86, s86, 10
    s_add_u32 s86, s86, 10485760
    buffer_load_dwordx4 v[52:55], v253, s[44:47], s86 offen sc1
    s_add_u32 s86, s86, 8192
    buffer_load_dwordx4 v[56:59], v253, s[44:47], s86 offen sc1
    s_add_u32 s86, s86, 8192
    buffer_load_dwordx4 v[60:63], v253, s[44:47], s86 offen sc1
    s_add_u32 s86, s86, 8192
    buffer_load_dwordx4 v[64:67], v253, s[44:47], s86 offen sc1
    s_add_u32 s86, s86, 8192
    buffer_load_dwordx4 v[68:71], v253, s[44:47], s86 offen sc1
    s_add_u32 s86, s86, 8192
    buffer_load_dwordx4 v[72:75], v253, s[44:47], s86 offen sc1
    s_add_u32 s86, s86, 8192
    buffer_load_dwordx4 v[76:79], v254, s[44:47], s86 offen sc1
    s_add_u32 s86, s3, 2
    s_and_b32 s86, s86, 3
    s_lshl2_add_u32 s86, s61, s86
    s_mul_i32 s86, s86, 54
    s_add_u32 s86, s86, s101
    s_lshl_b32 s86, s86, 10
    s_add_u32 s86, s86, 10485760
    buffer_load_dwordx4 v[80:83], v253, s[44:47], s86 offen sc1
    s_add_u32 s86, s86, 8192
    buffer_load_dwordx4 v[84:87], v253, s[44:47], s86 offen sc1
    s_add_u32 s86, s86, 8192
    buffer_load_dwordx4 v[88:91], v253, s[44:47], s86 offen sc1
    s_waitcnt lgkmcnt(0)
    s_barrier
    ds_read_b128 v[4:7], v2 offset:0
    ds_read_b128 v[8:11], v2 offset:1024
    ds_read_b128 v[12:15], v2 offset:2048
    ds_read_b128 v[16:19], v2 offset:3072
    ds_read_b128 v[20:23], v2 offset:4096
    s_waitcnt vmcnt(9)
    s_waitcnt lgkmcnt(4)
    v_mfma_f32_16x16x32_bf16 v[4:7], v[108:111], v[52:55], v[4:7]
    s_waitcnt lgkmcnt(3)
    v_mfma_f32_16x16x32_bf16 v[8:11], v[112:115], v[52:55], v[8:11]
    s_add_u32 s86, s86, 8192
    buffer_load_dwordx4 v[92:95], v253, s[44:47], s86 offen sc1
    s_waitcnt lgkmcnt(2)
    v_mfma_f32_16x16x32_bf16 v[12:15], v[116:119], v[52:55], v[12:15]
    s_waitcnt lgkmcnt(1)
    v_mfma_f32_16x16x32_bf16 v[16:19], v[120:123], v[52:55], v[16:19]
    s_waitcnt lgkmcnt(0)
    v_mfma_f32_16x16x32_bf16 v[20:23], v[124:127], v[52:55], v[20:23]
    s_waitcnt vmcnt(9)
    v_mfma_f32_16x16x32_bf16 v[4:7], v[128:131], v[56:59], v[4:7]
    v_mfma_f32_16x16x32_bf16 v[8:11], v[132:135], v[56:59], v[8:11]
    s_add_u32 s86, s86, 8192
    buffer_load_dwordx4 v[96:99], v253, s[44:47], s86 offen sc1
    v_mfma_f32_16x16x32_bf16 v[12:15], v[136:139], v[56:59], v[12:15]
    v_mfma_f32_16x16x32_bf16 v[16:19], v[140:143], v[56:59], v[16:19]
    v_mfma_f32_16x16x32_bf16 v[20:23], v[144:147], v[56:59], v[20:23]
    s_waitcnt vmcnt(9)
    v_mfma_f32_16x16x32_bf16 v[4:7], v[148:151], v[60:63], v[4:7]
    v_mfma_f32_16x16x32_bf16 v[8:11], v[152:155], v[60:63], v[8:11]
    s_add_u32 s86, s86, 8192
    buffer_load_dwordx4 v[100:103], v253, s[44:47], s86 offen sc1
    v_mfma_f32_16x16x32_bf16 v[12:15], v[156:159], v[60:63], v[12:15]
    v_mfma_f32_16x16x32_bf16 v[16:19], v[160:163], v[60:63], v[16:19]
    v_mfma_f32_16x16x32_bf16 v[20:23], v[164:167], v[60:63], v[20:23]
    s_waitcnt vmcnt(9)
    v_mfma_f32_16x16x32_bf16 v[4:7], v[168:171], v[64:67], v[4:7]
    v_mfma_f32_16x16x32_bf16 v[8:11], v[172:175], v[64:67], v[8:11]
    s_add_u32 s86, s86, 8192
    buffer_load_dwordx4 v[104:107], v254, s[44:47], s86 offen sc1
    v_mfma_f32_16x16x32_bf16 v[12:15], v[176:179], v[64:67], v[12:15]
    v_mfma_f32_16x16x32_bf16 v[16:19], v[180:183], v[64:67], v[16:19]
    v_mfma_f32_16x16x32_bf16 v[20:23], v[184:187], v[64:67], v[20:23]
    s_waitcnt vmcnt(9)
    v_mfma_f32_16x16x32_bf16 v[4:7], v[188:191], v[68:71], v[4:7]
    v_mfma_f32_16x16x32_bf16 v[8:11], v[192:195], v[68:71], v[8:11]
    s_add_u32 s86, s3, 3
    s_and_b32 s86, s86, 3
    s_lshl2_add_u32 s86, s61, s86
    s_mul_i32 s86, s86, 54
    s_add_u32 s86, s86, s101
    s_lshl_b32 s86, s86, 10
    s_add_u32 s86, s86, 10485760
    buffer_load_dwordx4 v[52:55], v253, s[44:47], s86 offen sc1
    v_mfma_f32_16x16x32_bf16 v[12:15], v[196:199], v[68:71], v[12:15]
    v_mfma_f32_16x16x32_bf16 v[16:19], v[200:203], v[68:71], v[16:19]
    v_mfma_f32_16x16x32_bf16 v[20:23], v[204:207], v[68:71], v[20:23]
    s_waitcnt vmcnt(9)
    v_mfma_f32_16x16x32_bf16 v[4:7], v[208:211], v[72:75], v[4:7]
    v_mfma_f32_16x16x32_bf16 v[8:11], v[212:215], v[72:75], v[8:11]
    s_add_u32 s86, s86, 8192
    buffer_load_dwordx4 v[56:59], v253, s[44:47], s86 offen sc1
    v_mfma_f32_16x16x32_bf16 v[12:15], v[216:219], v[72:75], v[12:15]
    v_mfma_f32_16x16x32_bf16 v[16:19], v[220:223], v[72:75], v[16:19]
    v_mfma_f32_16x16x32_bf16 v[20:23], v[224:227], v[72:75], v[20:23]
    s_waitcnt vmcnt(9)
    v_mfma_f32_16x16x32_bf16 v[4:7], v[228:231], v[76:79], v[4:7]
    v_mfma_f32_16x16x32_bf16 v[8:11], v[232:235], v[76:79], v[8:11]
    s_add_u32 s86, s86, 8192
    buffer_load_dwordx4 v[60:63], v253, s[44:47], s86 offen sc1
    v_mfma_f32_16x16x32_bf16 v[12:15], v[236:239], v[76:79], v[12:15]
    v_mfma_f32_16x16x32_bf16 v[16:19], v[240:243], v[76:79], v[16:19]
    v_mfma_f32_16x16x32_bf16 v[20:23], v[244:247], v[76:79], v[20:23]
    s_waitcnt lgkmcnt(0)
    s_barrier
    ds_read_b128 v[24:27], v2 offset:20480
    ds_read_b128 v[28:31], v2 offset:21504
    ds_read_b128 v[32:35], v2 offset:22528
    ds_read_b128 v[36:39], v2 offset:23552
    ds_read_b128 v[40:43], v2 offset:24576
    s_add_u32 s66, s3, 1
    s_and_b32 s66, s66, 3
    s_mul_i32 s66, s66, 15360
    s_add_u32 s66, s66, 57344
    v_add_u32 v3, s66, v253
    ds_write_b128 v3, v[4:7] offset:0
    ds_write_b128 v3, v[8:11] offset:1024
    ds_write_b128 v3, v[12:15] offset:2048
    ds_write_b128 v3, v[16:19] offset:3072
    ds_write_b128 v3, v[20:23] offset:4096
    s_waitcnt vmcnt(9)
    s_waitcnt lgkmcnt(9)
    v_mfma_f32_16x16x32_bf16 v[24:27], v[108:111], v[80:83], v[24:27]
    s_waitcnt lgkmcnt(8)
    v_mfma_f32_16x16x32_bf16 v[28:31], v[112:115], v[80:83], v[28:31]
    s_add_u32 s86, s86, 8192
    buffer_load_dwordx4 v[64:67], v253, s[44:47], s86 offen sc1
    s_waitcnt lgkmcnt(7)
    v_mfma_f32_16x16x32_bf16 v[32:35], v[116:119], v[80:83], v[32:35]
    s_waitcnt lgkmcnt(6)
    v_mfma_f32_16x16x32_bf16 v[36:39], v[120:123], v[80:83], v[36:39]
    s_waitcnt lgkmcnt(5)
    v_mfma_f32_16x16x32_bf16 v[40:43], v[124:127], v[80:83], v[40:43]
    s_waitcnt vmcnt(9)
    v_mfma_f32_16x16x32_bf16 v[24:27], v[128:131], v[84:87], v[24:27]
    v_mfma_f32_16x16x32_bf16 v[28:31], v[132:135], v[84:87], v[28:31]
    s_add_u32 s86, s86, 8192
    buffer_load_dwordx4 v[68:71], v253, s[44:47], s86 offen sc1
    v_mfma_f32_16x16x32_bf16 v[32:35], v[136:139], v[84:87], v[32:35]
    v_mfma_f32_16x16x32_bf16 v[36:39], v[140:143], v[84:87], v[36:39]
    v_mfma_f32_16x16x32_bf16 v[40:43], v[144:147], v[84:87], v[40:43]
    s_waitcnt vmcnt(9)
    v_mfma_f32_16x16x32_bf16 v[24:27], v[148:151], v[88:91], v[24:27]
    v_mfma_f32_16x16x32_bf16 v[28:31], v[152:155], v[88:91], v[28:31]
    s_add_u32 s86, s86, 8192
    buffer_load_dwordx4 v[72:75], v253, s[44:47], s86 offen sc1
    v_mfma_f32_16x16x32_bf16 v[32:35], v[156:159], v[88:91], v[32:35]
    v_mfma_f32_16x16x32_bf16 v[36:39], v[160:163], v[88:91], v[36:39]
    v_mfma_f32_16x16x32_bf16 v[40:43], v[164:167], v[88:91], v[40:43]
    s_waitcnt vmcnt(9)
    v_mfma_f32_16x16x32_bf16 v[24:27], v[168:171], v[92:95], v[24:27]
    v_mfma_f32_16x16x32_bf16 v[28:31], v[172:175], v[92:95], v[28:31]
    s_add_u32 s86, s86, 8192
    buffer_load_dwordx4 v[76:79], v254, s[44:47], s86 offen sc1
    v_mfma_f32_16x16x32_bf16 v[32:35], v[176:179], v[92:95], v[32:35]
    v_mfma_f32_16x16x32_bf16 v[36:39], v[180:183], v[92:95], v[36:39]
    v_mfma_f32_16x16x32_bf16 v[40:43], v[184:187], v[92:95], v[40:43]
    s_waitcnt vmcnt(9)
    v_mfma_f32_16x16x32_bf16 v[24:27], v[188:191], v[96:99], v[24:27]
    v_mfma_f32_16x16x32_bf16 v[28:31], v[192:195], v[96:99], v[28:31]
    s_add_u32 s86, s3, 4
    s_and_b32 s86, s86, 3
    s_lshl2_add_u32 s86, s61, s86
    s_mul_i32 s86, s86, 54
    s_add_u32 s86, s86, s101
    s_lshl_b32 s86, s86, 10
    s_add_u32 s86, s86, 10485760
    buffer_load_dwordx4 v[80:83], v253, s[44:47], s86 offen sc1
    v_mfma_f32_16x16x32_bf16 v[32:35], v[196:199], v[96:99], v[32:35]
    v_mfma_f32_16x16x32_bf16 v[36:39], v[200:203], v[96:99], v[36:39]
    v_mfma_f32_16x16x32_bf16 v[40:43], v[204:207], v[96:99], v[40:43]
    s_waitcnt vmcnt(9)
    v_mfma_f32_16x16x32_bf16 v[24:27], v[208:211], v[100:103], v[24:27]
    v_mfma_f32_16x16x32_bf16 v[28:31], v[212:215], v[100:103], v[28:31]
    s_add_u32 s86, s86, 8192
    buffer_load_dwordx4 v[84:87], v253, s[44:47], s86 offen sc1
    v_mfma_f32_16x16x32_bf16 v[32:35], v[216:219], v[100:103], v[32:35]
    v_mfma_f32_16x16x32_bf16 v[36:39], v[220:223], v[100:103], v[36:39]
    v_mfma_f32_16x16x32_bf16 v[40:43], v[224:227], v[100:103], v[40:43]
    s_waitcnt vmcnt(9)
    v_mfma_f32_16x16x32_bf16 v[24:27], v[228:231], v[104:107], v[24:27]
    v_mfma_f32_16x16x32_bf16 v[28:31], v[232:235], v[104:107], v[28:31]
    s_add_u32 s86, s86, 8192
    buffer_load_dwordx4 v[88:91], v253, s[44:47], s86 offen sc1
    v_mfma_f32_16x16x32_bf16 v[32:35], v[236:239], v[104:107], v[32:35]
    v_mfma_f32_16x16x32_bf16 v[36:39], v[240:243], v[104:107], v[36:39]
    v_mfma_f32_16x16x32_bf16 v[40:43], v[244:247], v[104:107], v[40:43]
    s_waitcnt lgkmcnt(0)
    s_barrier
    ds_read_b128 v[4:7], v2 offset:0
    ds_read_b128 v[8:11], v2 offset:1024
    ds_read_b128 v[12:15], v2 offset:2048
    ds_read_b128 v[16:19], v2 offset:3072
    ds_read_b128 v[20:23], v2 offset:4096
    s_add_u32 s66, s3, 2
    s_and_b32 s66, s66, 3
    s_mul_i32 s66, s66, 15360
    s_add_u32 s66, s66, 57344
    v_add_u32 v3, s66, v253
    ds_write_b128 v3, v[24:27] offset:5120
    ds_write_b128 v3, v[28:31] offset:6144
    ds_write_b128 v3, v[32:35] offset:7168
    ds_write_b128 v3, v[36:39] offset:8192
    ds_write_b128 v3, v[40:43] offset:9216
    s_waitcnt vmcnt(9)
    s_waitcnt lgkmcnt(9)
    v_mfma_f32_16x16x32_bf16 v[4:7], v[108:111], v[52:55], v[4:7]
    s_waitcnt lgkmcnt(8)
    v_mfma_f32_16x16x32_bf16 v[8:11], v[112:115], v[52:55], v[8:11]
    s_add_u32 s86, s86, 8192
    buffer_load_dwordx4 v[92:95], v253, s[44:47], s86 offen sc1
    s_waitcnt lgkmcnt(7)
    v_mfma_f32_16x16x32_bf16 v[12:15], v[116:119], v[52:55], v[12:15]
    s_waitcnt lgkmcnt(6)
    v_mfma_f32_16x16x32_bf16 v[16:19], v[120:123], v[52:55], v[16:19]
    s_waitcnt lgkmcnt(5)
    v_mfma_f32_16x16x32_bf16 v[20:23], v[124:127], v[52:55], v[20:23]
    s_waitcnt vmcnt(9)
    v_mfma_f32_16x16x32_bf16 v[4:7], v[128:131], v[56:59], v[4:7]
    v_mfma_f32_16x16x32_bf16 v[8:11], v[132:135], v[56:59], v[8:11]
    s_add_u32 s86, s86, 8192
    buffer_load_dwordx4 v[96:99], v253, s[44:47], s86 offen sc1
    v_mfma_f32_16x16x32_bf16 v[12:15], v[136:139], v[56:59], v[12:15]
    v_mfma_f32_16x16x32_bf16 v[16:19], v[140:143], v[56:59], v[16:19]
    v_mfma_f32_16x16x32_bf16 v[20:23], v[144:147], v[56:59], v[20:23]
    s_waitcnt vmcnt(9)
    v_mfma_f32_16x16x32_bf16 v[4:7], v[148:151], v[60:63], v[4:7]
    v_mfma_f32_16x16x32_bf16 v[8:11], v[152:155], v[60:63], v[8:11]
    s_add_u32 s86, s86, 8192
    buffer_load_dwordx4 v[100:103], v253, s[44:47], s86 offen sc1
    v_mfma_f32_16x16x32_bf16 v[12:15], v[156:159], v[60:63], v[12:15]
    v_mfma_f32_16x16x32_bf16 v[16:19], v[160:163], v[60:63], v[16:19]
    v_mfma_f32_16x16x32_bf16 v[20:23], v[164:167], v[60:63], v[20:23]
    s_waitcnt vmcnt(9)
    v_mfma_f32_16x16x32_bf16 v[4:7], v[168:171], v[64:67], v[4:7]
    v_mfma_f32_16x16x32_bf16 v[8:11], v[172:175], v[64:67], v[8:11]
    s_add_u32 s86, s86, 8192
    buffer_load_dwordx4 v[104:107], v254, s[44:47], s86 offen sc1
    v_mfma_f32_16x16x32_bf16 v[12:15], v[176:179], v[64:67], v[12:15]
    v_mfma_f32_16x16x32_bf16 v[16:19], v[180:183], v[64:67], v[16:19]
    v_mfma_f32_16x16x32_bf16 v[20:23], v[184:187], v[64:67], v[20:23]
    s_waitcnt vmcnt(9)
    v_mfma_f32_16x16x32_bf16 v[4:7], v[188:191], v[68:71], v[4:7]
    v_mfma_f32_16x16x32_bf16 v[8:11], v[192:195], v[68:71], v[8:11]
    v_mfma_f32_16x16x32_bf16 v[12:15], v[196:199], v[68:71], v[12:15]
    v_mfma_f32_16x16x32_bf16 v[16:19], v[200:203], v[68:71], v[16:19]
    v_mfma_f32_16x16x32_bf16 v[20:23], v[204:207], v[68:71], v[20:23]
    s_waitcnt vmcnt(8)
    v_mfma_f32_16x16x32_bf16 v[4:7], v[208:211], v[72:75], v[4:7]
    v_mfma_f32_16x16x32_bf16 v[8:11], v[212:215], v[72:75], v[8:11]
    v_mfma_f32_16x16x32_bf16 v[12:15], v[216:219], v[72:75], v[12:15]
    v_mfma_f32_16x16x32_bf16 v[16:19], v[220:223], v[72:75], v[16:19]
    v_mfma_f32_16x16x32_bf16 v[20:23], v[224:227], v[72:75], v[20:23]
    s_waitcnt vmcnt(7)
    v_mfma_f32_16x16x32_bf16 v[4:7], v[228:231], v[76:79], v[4:7]
    v_mfma_f32_16x16x32_bf16 v[8:11], v[232:235], v[76:79], v[8:11]
    v_mfma_f32_16x16x32_bf16 v[12:15], v[236:239], v[76:79], v[12:15]
    v_mfma_f32_16x16x32_bf16 v[16:19], v[240:243], v[76:79], v[16:19]
    v_mfma_f32_16x16x32_bf16 v[20:23], v[244:247], v[76:79], v[20:23]
    s_waitcnt lgkmcnt(0)
    s_barrier
    ds_read_b128 v[24:27], v47 offset:0
    ds_read_b128 v[28:31], v47 offset:1024
    ds_read_b128 v[32:35], v47 offset:2048
    ds_read_b128 v[36:39], v47 offset:3072
    ds_read_b128 v[40:43], v47 offset:4096
    s_add_u32 s66, s3, 3
    s_and_b32 s66, s66, 3
    s_mul_i32 s66, s66, 15360
    s_add_u32 s66, s66, 57344
    v_add_u32 v3, s66, v253
    ds_write_b128 v3, v[4:7] offset:10240
    ds_write_b128 v3, v[8:11] offset:11264
    ds_write_b128 v3, v[12:15] offset:12288
    ds_write_b128 v3, v[16:19] offset:13312
    ds_write_b128 v3, v[20:23] offset:14336
    s_waitcnt vmcnt(6)
    s_waitcnt lgkmcnt(9)
    v_mfma_f32_16x16x32_bf16 v[24:27], v[108:111], v[80:83], v[24:27]
    s_waitcnt lgkmcnt(8)
    v_mfma_f32_16x16x32_bf16 v[28:31], v[112:115], v[80:83], v[28:31]
    s_waitcnt lgkmcnt(7)
    v_mfma_f32_16x16x32_bf16 v[32:35], v[116:119], v[80:83], v[32:35]
    s_waitcnt lgkmcnt(6)
    v_mfma_f32_16x16x32_bf16 v[36:39], v[120:123], v[80:83], v[36:39]
    s_waitcnt lgkmcnt(5)
    v_mfma_f32_16x16x32_bf16 v[40:43], v[124:127], v[80:83], v[40:43]
    s_waitcnt vmcnt(5)
    v_mfma_f32_16x16x32_bf16 v[24:27], v[128:131], v[84:87], v[24:27]
    v_mfma_f32_16x16x32_bf16 v[28:31], v[132:135], v[84:87], v[28:31]
    v_mfma_f32_16x16x32_bf16 v[32:35], v[136:139], v[84:87], v[32:35]
    v_mfma_f32_16x16x32_bf16 v[36:39], v[140:143], v[84:87], v[36:39]
    v_mfma_f32_16x16x32_bf16 v[40:43], v[144:147], v[84:87], v[40:43]
    s_waitcnt vmcnt(4)
    v_mfma_f32_16x16x32_bf16 v[24:27], v[148:151], v[88:91], v[24:27]
    v_mfma_f32_16x16x32_bf16 v[28:31], v[152:155], v[88:91], v[28:31]
    v_mfma_f32_16x16x32_bf16 v[32:35], v[156:159], v[88:91], v[32:35]
    v_mfma_f32_16x16x32_bf16 v[36:39], v[160:163], v[88:91], v[36:39]
    v_mfma_f32_16x16x32_bf16 v[40:43], v[164:167], v[88:91], v[40:43]
    s_waitcnt vmcnt(3)
    v_mfma_f32_16x16x32_bf16 v[24:27], v[168:171], v[92:95], v[24:27]
    v_mfma_f32_16x16x32_bf16 v[28:31], v[172:175], v[92:95], v[28:31]
    v_mfma_f32_16x16x32_bf16 v[32:35], v[176:179], v[92:95], v[32:35]
    v_mfma_f32_16x16x32_bf16 v[36:39], v[180:183], v[92:95], v[36:39]
    v_mfma_f32_16x16x32_bf16 v[40:43], v[184:187], v[92:95], v[40:43]
    s_waitcnt vmcnt(2)
    v_mfma_f32_16x16x32_bf16 v[24:27], v[188:191], v[96:99], v[24:27]
    v_mfma_f32_16x16x32_bf16 v[28:31], v[192:195], v[96:99], v[28:31]
    v_mfma_f32_16x16x32_bf16 v[32:35], v[196:199], v[96:99], v[32:35]
    v_mfma_f32_16x16x32_bf16 v[36:39], v[200:203], v[96:99], v[36:39]
    v_mfma_f32_16x16x32_bf16 v[40:43], v[204:207], v[96:99], v[40:43]
    s_waitcnt lgkmcnt(0)
    s_barrier
    ds_read_b128 v[108:111], v48 offset:0
    ds_read_b128 v[128:131], v47 offset:5120
    ds_read_b128 v[112:115], v48 offset:1024
    ds_read_b128 v[132:135], v47 offset:6144
    ds_read_b128 v[116:119], v48 offset:2048
    ds_read_b128 v[136:139], v47 offset:7168
    ds_read_b128 v[120:123], v48 offset:3072
    ds_read_b128 v[140:143], v47 offset:8192
    ds_read_b128 v[124:127], v48 offset:4096
    ds_read_b128 v[144:147], v47 offset:9216
    s_waitcnt vmcnt(1)
    v_mfma_f32_16x16x32_bf16 v[24:27], v[208:211], v[100:103], v[24:27]
    v_mfma_f32_16x16x32_bf16 v[28:31], v[212:215], v[100:103], v[28:31]
    v_mfma_f32_16x16x32_bf16 v[32:35], v[216:219], v[100:103], v[32:35]
    v_mfma_f32_16x16x32_bf16 v[36:39], v[220:223], v[100:103], v[36:39]
    v_mfma_f32_16x16x32_bf16 v[40:43], v[224:227], v[100:103], v[40:43]
    s_waitcnt vmcnt(0)
    v_mfma_f32_16x16x32_bf16 v[24:27], v[228:231], v[104:107], v[24:27]
    v_sub_f32 v1, 1.0, v1
    s_waitcnt lgkmcnt(8)
    v_mfma_f32_16x16x32_bf16 v[28:31], v[232:235], v[104:107], v[28:31]
    v_fmac_f32 v108, v1, v128
    v_fmac_f32 v109, v1, v129
    v_mfma_f32_16x16x32_bf16 v[32:35], v[236:239], v[104:107], v[32:35]
    v_fmac_f32 v110, v1, v130
    v_fmac_f32 v111, v1, v131
    v_mfma_f32_16x16x32_bf16 v[36:39], v[240:243], v[104:107], v[36:39]
    s_waitcnt lgkmcnt(6)
    v_fmac_f32 v112, v1, v132
    v_mfma_f32_16x16x32_bf16 v[40:43], v[244:247], v[104:107], v[40:43]
    v_fmac_f32 v113, v1, v133
    v_fmac_f32 v114, v1, v134
    v_fmac_f32 v115, v1, v135
    s_waitcnt lgkmcnt(4)
    v_fmac_f32 v116, v1, v136
    v_fmac_f32 v117, v1, v137
    v_fmac_f32 v118, v1, v138
    v_fmac_f32 v119, v1, v139
    s_waitcnt lgkmcnt(2)
    v_fmac_f32 v120, v1, v140
    v_fmac_f32 v121, v1, v141
    v_fmac_f32 v122, v1, v142
    v_fmac_f32 v123, v1, v143
    s_waitcnt lgkmcnt(0)
    v_fmac_f32 v124, v1, v144
    v_fmac_f32 v125, v1, v145
    v_fmac_f32 v126, v1, v146
    v_fmac_f32 v127, v1, v147
    v_fmac_f32 v108, v1, v24
    v_fmac_f32 v109, v1, v25
    v_fmac_f32 v110, v1, v26
    v_fmac_f32 v111, v1, v27
    v_fmac_f32 v112, v1, v28
    v_fmac_f32 v113, v1, v29
    v_fmac_f32 v114, v1, v30
    v_fmac_f32 v115, v1, v31
    v_cvt_pk_bf16_f32 v4, v108, v109
    v_cvt_pk_bf16_f32 v5, v110, v111
    v_cvt_pk_bf16_f32 v6, v112, v113
    v_cvt_pk_bf16_f32 v7, v114, v115
    buffer_store_dwordx4 v[4:7], v45, s[52:55], s87 offen offset:0 nt
    v_fmac_f32 v116, v1, v32
    v_fmac_f32 v117, v1, v33
    v_fmac_f32 v118, v1, v34
    v_fmac_f32 v119, v1, v35
    v_fmac_f32 v120, v1, v36
    v_fmac_f32 v121, v1, v37
    v_fmac_f32 v122, v1, v38
    v_fmac_f32 v123, v1, v39
    v_cvt_pk_bf16_f32 v8, v116, v117
    v_cvt_pk_bf16_f32 v9, v118, v119
    v_cvt_pk_bf16_f32 v10, v120, v121
    v_cvt_pk_bf16_f32 v11, v122, v123
    buffer_store_dwordx4 v[8:11], v45, s[52:55], s87 offen offset:64 nt
    v_fmac_f32 v124, v1, v40
    v_fmac_f32 v125, v1, v41
    v_fmac_f32 v126, v1, v42
    v_fmac_f32 v127, v1, v43
    v_cvt_pk_bf16_f32 v12, v124, v125
    v_cvt_pk_bf16_f32 v13, v126, v127
    buffer_store_dwordx2 v[12:13], v46, s[52:55], s87 offen offset:128 nt
    s_branch gated_mix__ssm_conv_s4d__mixer_channel_mlp__prompt_kernel_end
gated_mix__ssm_conv_s4d__mixer_channel_mlp__prompt_kernel_fh:
    s_lshl_b32 s66, s3, 6
    v_add_u32 v1, s66, v0
    v_mul_u32_u24 v12, 6554, v1
    v_mul_u32_u24 v13, 3277, v1
    v_lshrrev_b32 v12, 16, v12
    v_lshrrev_b32 v13, 16, v13
    v_mul_u32_u24 v12, 1120, v12
    v_mul_u32_u24 v13, 960, v13
    v_lshl_add_u32 v2, v1, 4, v12
    v_lshl_add_u32 v5, v1, 4, v13
    v_add_u32 v1, 256, v1
    v_mul_u32_u24 v12, 6554, v1
    v_mul_u32_u24 v13, 3277, v1
    v_lshrrev_b32 v12, 16, v12
    v_lshrrev_b32 v13, 16, v13
    v_mul_u32_u24 v12, 1120, v12
    v_mul_u32_u24 v13, 960, v13
    v_lshl_add_u32 v3, v1, 4, v12
    v_lshl_add_u32 v6, v1, 4, v13
    v_add_u32 v1, 256, v1
    v_mul_u32_u24 v12, 6554, v1
    v_mul_u32_u24 v13, 3277, v1
    v_lshrrev_b32 v12, 16, v12
    v_lshrrev_b32 v13, 16, v13
    v_mul_u32_u24 v12, 1120, v12
    v_mul_u32_u24 v13, 960, v13
    v_lshl_add_u32 v4, v1, 4, v12
    v_lshl_add_u32 v7, v1, 4, v13
    v_and_b32 v1, 31, v0
    v_lshlrev_b32 v10, 4, v1
    v_lshlrev_b32 v11, 3, v1
    v_lshrrev_b32 v12, 5, v0
    v_mul_u32_u24 v12, 1280, v12
    v_add_u32 v8, v12, v10
    v_add_u32 v9, v12, v11
    s_mul_i32 s68, s61, 81920
    s_mul_i32 s66, s62, 160
    s_add_u32 s68, s68, s66
    s_lshr_b32 s66, s2, 2
    s_mul_i32 s70, s66, 40960
    s_and_b32 s66, s2, 3
    s_mul_i32 s66, s66, 320
    s_add_u32 s70, s70, s66
    s_cmp_ge_u32 s3, 2
    s_cselect_b32 s69, 1073741824, s68
    s_cselect_b32 s71, 1073741824, s70
    s_lshl_b32 s72, s56, 5
    s_add_u32 s72, s72, s57
    s_lshl2_add_u32 s72, s72, s3
    s_mul_i32 s72, s72, 2560
    s_lshl_b32 s73, s3, 10
    s_lshl2_add_u32 s66, s60, s3
    s_lshl_b32 s67, s66, 7
    v_lshl_add_u32 v70, v0, 1, s67
    s_and_b32 s66, s66, -2
    v_mov_b32 v71, s66
    s_waitcnt lgkmcnt(0)
    s_mov_b64 s[36:37], s[4:5]
    s_mov_b64 s[40:41], s[20:21]
    s_mov_b64 s[44:45], s[34:35]
    s_mov_b64 s[48:49], s[24:25]
    s_mov_b64 s[52:53], s[30:31]
    s_mov_b64 s[92:93], s[32:33]
    s_add_u32 m0, s73, 131072
    s_nop 0
    buffer_load_dwordx4 v2, s[36:39], s68 offen lds
    s_add_u32 m0, s73, 135168
    s_nop 0
    buffer_load_dwordx4 v3, s[36:39], s68 offen lds
    s_add_u32 m0, s73, 139264
    s_nop 0
    buffer_load_dwordx4 v4, s[36:39], s69 offen lds
    s_add_u32 m0, s73, 143360
    s_nop 0
    buffer_load_dwordx4 v5, s[48:51], s70 offen lds
    s_add_u32 m0, s73, 147456
    s_nop 0
    buffer_load_dwordx4 v6, s[48:51], s70 offen lds
    s_add_u32 m0, s73, 151552
    s_nop 0
    buffer_load_dwordx4 v7, s[48:51], s71 offen lds
    buffer_load_dwordx4 v[16:19], v8, s[36:39], s72 offen
    buffer_load_dwordx4 v[20:23], v8, s[36:39], s72 offen offset:512
    buffer_load_dwordx2 v[24:25], v9, s[36:39], s72 offen offset:1024
    global_load_dwordx4 v[28:31], v10, s[28:29]
    global_load_dwordx4 v[32:35], v10, s[28:29] offset:512
    global_load_dwordx2 v[36:37], v11, s[28:29] offset:1024
    global_load_ushort v64, v70, s[6:7] offset:0
    global_load_ushort v65, v70, s[8:9] offset:0
    global_load_ushort v66, v70, s[10:11] offset:0
    global_load_ushort v67, v70, s[12:13] offset:0
    global_load_ushort v68, v71, s[14:15] offset:0
    global_load_ushort v69, v71, s[16:17] offset:0
    v_cmp_gt_u32 s[90:91], 8, v0
    v_mov_b32 v252, 1073741824
    v_lshlrev_b32 v251, 8, v0
    v_cndmask_b32 v251, v252, v251, s[90:91]
    v_mov_b32 v252, 1
    v_lshrrev_b32 v8, 4, v0
    v_bfe_u32 v9, v0, 2, 2
    v_and_b32 v10, 3, v0
    v_lshl_add_u32 v11, v8, 3, v9
    v_mul_u32_u24 v11, 160, v11
    v_lshl_add_u32 v11, v10, 3, v11
    s_and_b32 s66, s3, 1
    s_mul_i32 s67, s66, 5120
    s_lshr_b32 s74, s3, 1
    s_lshl_b32 s75, s74, 5
    s_add_u32 s67, s67, s75
    s_add_u32 s67, s67, 131072
    v_add_u32 v2, s67, v11
    v_lshrrev_b32 v11, 5, v0
    v_lshl_add_u32 v11, v11, 4, v9
    v_and_b32 v12, 16, v0
    v_lshrrev_b32 v12, 2, v12
    v_add_u32 v11, v11, v12
    v_mul_u32_u24 v11, 320, v11
    s_lshl_b32 s67, s74, 6
    s_lshl3_add_u32 s67, s66, s67
    s_add_u32 s67, s67, 143360
    v_lshl_add_u32 v3, v10, 4, v11
    v_add_u32 v3, s67, v3
    s_mul_i32 s67, s66, 160
    s_add_u32 s67, s67, 143488
    v_lshl_add_u32 v4, v10, 3, v11
    v_add_u32 v4, s67, v4
    v_bfe_u32 v9, v0, 1, 3
    v_mul_u32_u24 v9, 8192, v9
    v_lshl_add_u32 v9, v8, 4, v9
    v_and_b32 v10, 1, v0
    v_lshl_add_u32 v5, v10, 6, v9
    v_lshlrev_b32 v6, 4, v0
    v_and_b32 v7, 32, v0
    v_and_b32 v8, 31, v0
    v_cmp_eq_u32 vcc, 16, v8
    v_mov_b32 v8, 1073741824
    s_nop 0
    v_cndmask_b32 v7, v8, v7, vcc
    s_mul_i32 s68, s62, 5
    s_add_u32 s68, s68, s74
    s_mul_i32 s68, s68, 65536
    s_lshl1_add_u32 s67, s61, s66
    s_lshl_b32 s67, s67, 7
    s_add_u32 s68, s68, s67
    s_add_u32 s68, s68, 1048576
    s_add_u32 s69, s68, 131072
    s_add_u32 s70, s68, 262144
    s_and_b32 s67, s2, 3
    s_mul_i32 s67, s67, 108
    s_lshr_b32 s71, s2, 2
    s_add_u32 s67, s67, s71
    s_mul_i32 s67, s67, 5120
    s_add_u32 s67, s67, 7340032
    s_cmp_ge_u32 s2, 216
    s_cselect_b32 s67, 1073741824, s67
    s_add_u32 s71, s67, s73
    s_add_u32 s72, s71, 276480
    s_mul_i32 s75, s66, 276480
    s_add_u32 s75, s75, s67
    s_add_u32 s75, s75, 4096
    s_cmp_ge_u32 s3, 2
    s_cselect_b32 s70, 1073741824, s70
    s_cselect_b32 s75, 1073741824, s75
    s_lshl_b32 s76, s56, 5
    s_add_u32 s76, s76, s57
    s_lshl2_add_u32 s76, s76, s3
    s_lshl_b32 s76, s76, 6
    s_add_u32 s76, s76, 65536
    s_cmp_eq_u32 s3, 0
    s_cselect_b32 s89, 1, 0
    v_cmp_gt_u32 s[90:91], s89, v0
    v_lshlrev_b32 v248, 8, v0
    v_mov_b32 v249, 1073741824
    v_cndmask_b32 v248, v249, v248, s[90:91]
    v_cndmask_b32 v249, 0, 1, s[90:91]
    v_lshlrev_b32 v253, 4, v0
    s_cmp_ge_u32 s101, 6
    s_cselect_b32 s66, 1073741824, 0
    v_add_u32 v254, s66, v253
    s_mul_i32 s85, s62, 54
    s_add_u32 s85, s85, s101
    s_mul_i32 s85, s85, 5120
    s_add_u32 s85, s85, 7340032
    s_mul_i32 s98, s56, 8
    s_add_u32 s98, s98, 0
    s_lshl_b32 s98, s98, 8
    s_cmp_eq_u32 s3, 0
    s_cselect_b32 s98, s98, 1073741824
    s_mov_b32 s64, 0
    s_mov_b32 s65, 1
    s_mov_b32 s81, 0
    s_waitcnt vmcnt(0)
    s_barrier
    ds_read_b64_tr_b16 v[40:41], v2 offset:0
    ds_read_b64_tr_b16 v[42:43], v2 offset:640
    ds_read_b64_tr_b16 v[44:45], v2 offset:64
    ds_read_b64_tr_b16 v[46:47], v2 offset:704
    ds_read_b64_tr_b16 v[48:49], v2 offset:128
    ds_read_b64_tr_b16 v[50:51], v2 offset:768
    ds_read_b64_tr_b16 v[52:53], v3 offset:0
    ds_read_b64_tr_b16 v[54:55], v3 offset:2560
    ds_read_b64_tr_b16 v[56:57], v3 offset:160
    ds_read_b64_tr_b16 v[58:59], v3 offset:2720
    ds_read_b64_tr_b16 v[60:61], v4 offset:0
    ds_read_b64_tr_b16 v[62:63], v4 offset:2560
    v_dot2_f32_bf16 v12, v16, s63, 0
    v_dot2_f32_bf16 v13, v16, v16, 0
    v_dot2_f32_bf16 v14, v16, v28, 0
    v_dot2_f32_bf16 v12, v17, s63, v12
    v_dot2_f32_bf16 v13, v17, v17, v13
    v_dot2_f32_bf16 v14, v17, v29, v14
    v_dot2_f32_bf16 v12, v18, s63, v12
    v_dot2_f32_bf16 v13, v18, v18, v13
    v_dot2_f32_bf16 v14, v18, v30, v14
    s_waitcnt lgkmcnt(0)
    buffer_store_dwordx4 v[40:43], v5, s[44:47], s68 offen sc1
    v_dot2_f32_bf16 v12, v19, s63, v12
    v_dot2_f32_bf16 v13, v19, v19, v13
    v_dot2_f32_bf16 v14, v19, v31, v14
    buffer_store_dwordx4 v[44:47], v5, s[44:47], s69 offen sc1
    v_dot2_f32_bf16 v12, v20, s63, v12
    v_dot2_f32_bf16 v13, v20, v20, v13
    v_dot2_f32_bf16 v14, v20, v32, v14
    buffer_store_dwordx4 v[48:51], v5, s[44:47], s70 offen sc1
    v_dot2_f32_bf16 v12, v21, s63, v12
    v_dot2_f32_bf16 v13, v21, v21, v13
    v_dot2_f32_bf16 v14, v21, v33, v14
    buffer_store_dwordx4 v[52:55], v6, s[44:47], s71 offen sc1
    v_dot2_f32_bf16 v12, v22, s63, v12
    v_dot2_f32_bf16 v13, v22, v22, v13
    v_dot2_f32_bf16 v14, v22, v34, v14
    buffer_store_dwordx4 v[56:59], v6, s[44:47], s72 offen sc1
    v_dot2_f32_bf16 v12, v23, s63, v12
    v_dot2_f32_bf16 v13, v23, v23, v13
    v_dot2_f32_bf16 v14, v23, v35, v14
    buffer_store_dwordx4 v[60:63], v6, s[44:47], s75 offen sc1
    v_dot2_f32_bf16 v12, v24, s63, v12
    v_dot2_f32_bf16 v13, v24, v24, v13
    v_dot2_f32_bf16 v14, v24, v36, v14
    v_dot2_f32_bf16 v12, v25, s63, v12
    v_dot2_f32_bf16 v13, v25, v25, v13
    v_dot2_f32_bf16 v14, v25, v37, v14
    s_nop 0
    v_add_f32 v12, v12, v12 row_ror:8
    v_add_f32 v13, v13, v13 row_ror:8
    v_add_f32 v14, v14, v14 row_ror:8
    v_add_f32 v12, v12, v12 row_ror:4
    v_add_f32 v13, v13, v13 row_ror:4
    v_add_f32 v14, v14, v14 row_ror:4
    v_add_f32 v12, v12, v12 row_ror:2
    v_add_f32 v13, v13, v13 row_ror:2
    v_add_f32 v14, v14, v14 row_ror:2
    v_add_f32 v12, v12, v12 row_ror:1
    v_add_f32 v13, v13, v13 row_ror:1
    v_add_f32 v14, v14, v14 row_ror:1
    v_add_f32 v12, v12, v12 row_bcast:15 row_mask:0xa
    v_add_f32 v13, v13, v13 row_bcast:15 row_mask:0xa
    v_add_f32 v14, v14, v14 row_bcast:15 row_mask:0xa
    v_mul_f32 v12, 0xbacccccd, v12
    v_mul_f32 v13, 0x3acccccd, v13
    v_mul_f32 v14, 0xbfb8aa3b, v14
    v_fma_f32 v13, -v12, v12, v13
    v_exp_f32 v14, v14
    v_max_f32 v13, 0, v13
    v_add_f32 v13, 0x3727c5ac, v13
    v_cvt_pk_bf16_f32 v16, v12, v12
    v_rsq_f32 v15, v13
    v_sqrt_f32 v22, v13
    v_add_f32 v14, 1.0, v14
    v_and_b32 v17, 0xffff0000, v16
    v_rcp_f32 v23, v14
    v_sub_f32 v17, v12, v17
    v_cvt_pk_bf16_f32 v18, v22, v22
    v_cvt_pk_bf16_f32 v17, v17, v17
    v_and_b32 v18, 0xffff0000, v18
    v_sub_f32 v19, v22, v18
    v_cvt_pk_bf16_f32 v18, v18, v19
    v_mov_b32 v19, 0
    v_mul_f32 v20, 0xc0135761, v15
    v_mul_f32 v21, v15, v15
    v_mul_f32 v21, 0x3d372713, v21
    v_mul_f32 v21, v20, v21
    buffer_store_dwordx4 v[16:19], v7, s[44:47], s76 offen sc1
    buffer_store_dwordx4 v[20:23], v7, s[44:47], s76 offen offset:16 sc1
    buffer_load_dword v250, v248, s[92:95], 0 offen sc1
    s_barrier
    s_waitcnt vmcnt(0)
    s_waitcnt vmcnt(0)
    s_mov_b32 s89, 0x20000
gated_mix__ssm_conv_s4d__mixer_channel_mlp__prompt_kernel_sp7:
    v_cmp_ne_u32 s[90:91], v249, v250
    s_sub_u32 s89, s89, 1
    s_cselect_b64 s[90:91], 0, s[90:91]
    s_cmp_eq_u64 s[90:91], 0
    s_cbranch_scc1 gated_mix__ssm_conv_s4d__mixer_channel_mlp__prompt_kernel_sd8
    s_nop 0
    buffer_load_dword v250, v248, s[92:95], 0 offen sc1
    s_waitcnt vmcnt(0)
    s_branch gated_mix__ssm_conv_s4d__mixer_channel_mlp__prompt_kernel_sp7
gated_mix__ssm_conv_s4d__mixer_channel_mlp__prompt_kernel_sd8:
    s_barrier
    buffer_atomic_add v252, v251, s[44:47], s98 offen sc1
    s_mov_b32 s89, 8
    v_cmp_gt_u32 s[90:91], s89, v0
    v_lshlrev_b32 v248, 11, v0
    v_mov_b32 v249, 1073741824
    v_cndmask_b32 v248, v249, v248, s[90:91]
    v_cndmask_b32 v249, 0, 32, s[90:91]
    s_and_b32 s89, s2, 7
    s_lshl_b32 s89, s89, 8
    v_add_u32 v248, s89, v248
    s_lshr_b32 s66, s3, 1
    s_mul_i32 s66, s66, 32736
    s_add_u32 s66, s66, 0
    s_and_b32 s67, s3, 1
    s_lshl_b32 s67, s67, 8
    s_add_u32 s67, s67, s66
    v_lshl_add_u32 v52, v0, 2, s67
    v_and_b32 v58, 31, v0
    v_lshrrev_b32 v59, 5, v0
    v_mul_u32_u24 v54, 528, v58
    v_lshl_add_u32 v54, v59, 4, v54
    v_add_u32 v54, s66, v54
    v_cmp_lt_u32 vcc, 27, v58
    v_subrev_u32 v53, 528, v54
    s_nop 0
    v_cndmask_b32 v53, v54, v53, vcc
    s_mul_i32 s66, s3, 4160
    s_add_u32 s66, s66, s64
    v_lshlrev_b32 v58, 4, v58
    v_sub_u32 v58, s66, v58
    v_lshlrev_b32 v57, 3, v59
    v_sub_u32 v55, v58, v57
    v_lshlrev_b32 v57, 9, v59
    v_sub_u32 v56, v58, v57
    v_and_b32 v57, 7, v0
    v_lshl_add_u32 v57, v57, 2, s66
    v_add_u32 v55, 3576, v55
    v_add_u32 v56, 1008, v56
    v_mov_b32 v58, 0x3f80
    s_barrier
    s_branch gated_mix__ssm_conv_s4d__mixer_channel_mlp__prompt_kernel_f2
gated_mix__ssm_conv_s4d__mixer_channel_mlp__prompt_kernel_f3:
    buffer_load_dword v250, v248, s[44:47], 0 offen sc1
    s_cmp_eq_u32 s100, 0
    s_cselect_b32 s64, 16640, 0
    s_cselect_b32 s81, -65792, 0
    s_cselect_b32 s65, 16384, 0
    s_addc_u32 s60, s60, 0
    v_bfe_u32 v1, v0, 2, 1
    v_mul_u32_u24 v1, 4608, v1
    v_lshrrev_b32 v3, 3, v0
    v_lshl_add_u32 v1, v3, 6, v1
    v_and_b32 v3, 3, v0
    v_lshl_add_u32 v1, v3, 4, v1
    s_lshl_b32 s66, s3, 10
    s_add_u32 s66, s66, 148224
    v_add_u32 v1, s66, v1
    s_lshr_b32 s74, s3, 1
    s_and_b32 s75, s3, 1
    s_mul_i32 s66, s74, 4608
    s_add_u32 s66, s66, 147712
    s_lshl_b32 s70, s75, 8
    s_add_u32 s67, s66, s70
    v_lshl_add_u32 v2, v0, 2, s67
    s_sub_u32 s66, s66, s70
    s_add_u32 s66, s66, 288
    v_and_b32 v9, 15, v0
    v_lshrrev_b32 v10, 4, v0
    v_lshl_add_u32 v3, v9, 5, s66
    v_lshl_add_u32 v3, v10, 4, v3
    s_mul_i32 s66, s74, 8320
    s_add_u32 s66, s66, s64
    s_sub_u32 s66, s66, s70
    s_add_u32 s66, s66, 7520
    v_and_b32 v7, 1, v0
    v_mul_u32_u24 v7, 4164, v7
    v_and_b32 v4, 14, v0
    v_lshl_add_u32 v7, v4, 1, v7
    v_sub_u32 v7, s66, v7
    v_lshl_add_u32 v4, v10, 4, v7
    v_subrev_u32 v5, 1024, v4
    v_subrev_u32 v6, 2048, v4
    v_subrev_u32 v7, 3072, v4
    v_lshlrev_b32 v8, 6, v9
    v_lshl_add_u32 v8, v10, 4, v8
    v_mov_b32 v11, 0
    s_mul_i32 s66, s3, 4096
    s_add_u32 s66, s66, 40960
    v_lshl_add_u32 v9, v0, 4, s66
    s_xor_b32 s66, s3, 1
    s_mul_i32 s66, s66, 4096
    s_add_u32 s66, s66, 40960
    v_lshl_add_u32 v10, v0, 4, s66
    v_add_u32 v1, s81, v1
    v_add_u32 v2, s81, v2
    v_add_u32 v3, s81, v3
    v_add_u32 v9, s65, v9
    v_add_u32 v10, s65, v10
    s_waitcnt vmcnt(0)
    s_mov_b32 s89, 0x20000
gated_mix__ssm_conv_s4d__mixer_channel_mlp__prompt_kernel_sp9:
    v_cmp_ne_u32 s[90:91], v249, v250
    s_sub_u32 s89, s89, 1
    s_cselect_b64 s[90:91], 0, s[90:91]
    s_cmp_eq_u64 s[90:91], 0
    s_cbranch_scc1 gated_mix__ssm_conv_s4d__mixer_channel_mlp__prompt_kernel_sd10
    s_nop 0
    buffer_load_dword v250, v248, s[44:47], 0 offen sc1
    s_waitcnt vmcnt(0)
    s_branch gated_mix__ssm_conv_s4d__mixer_channel_mlp__prompt_kernel_sp9
gated_mix__ssm_conv_s4d__mixer_channel_mlp__prompt_kernel_sd10:
    s_mul_i32 s76, s60, 8192
    s_lshl_b32 s72, s3, 11
    s_add_u32 s76, s76, s72
    s_add_u32 s76, s76, 1048576
    buffer_load_dwordx4 v[168:171], v253, s[44:47], s76 offen offset:0 sc1
    buffer_load_dwordx4 v[172:175], v253, s[44:47], s76 offen offset:1024 sc1
    s_cmp_eq_u32 s100, 0
    s_cselect_b64 vcc, -1, 0
    s_waitcnt vmcnt(0)
    ds_write_b128 v1, v[168:171]
    ds_write_b128 v1, v[172:175] offset:512
    ds_write_b32 v2, v11
    s_lshl1_add_u32 s71, s60, s74
    s_mul_i32 s71, s71, 4096
    s_lshl_b32 s72, s75, 11
    s_add_u32 s71, s71, s72
    s_add_u32 s71, s71, 4194304
    s_waitcnt lgkmcnt(0)
    s_barrier
    s_cbranch_vccnz gated_mix__ssm_conv_s4d__mixer_channel_mlp__prompt_kernel_ho11
    s_add_u32 s60, s60, 2
    s_mul_i32 s76, s60, 8192
    s_lshl_b32 s72, s3, 11
    s_add_u32 s76, s76, s72
    s_add_u32 s76, s76, 1048576
    buffer_load_dwordx4 v[168:171], v253, s[44:47], s76 offen offset:0 sc1
    buffer_load_dwordx4 v[172:175], v253, s[44:47], s76 offen offset:1024 sc1
gated_mix__ssm_conv_s4d__mixer_channel_mlp__prompt_kernel_ho11:
    ds_read_b128 v[104:107], v3 offset:3776
    ds_read2_b32 v[44:45], v4 offset0:176 offset1:177
    ds_read2_b32 v[46:47], v4 offset0:178 offset1:179
    ds_read_b128 v[100:103], v3 offset:3264
    ds_read_b128 v[96:99], v3 offset:2752
    ds_read_b128 v[92:95], v3 offset:2240
    ds_read_b128 v[88:91], v3 offset:1728
    ds_read_b128 v[84:87], v3 offset:1216
    ds_read_b128 v[80:83], v3 offset:704
    ds_read_b128 v[76:79], v3 offset:192
    s_waitcnt lgkmcnt(7)
    v_mfma_f32_16x16x32_bf16 v[40:43], v[44:47], v[104:107], 0
    ds_read_b128 v[104:107], v3 offset:3712
    s_waitcnt lgkmcnt(7)
    v_mfma_f32_16x16x32_bf16 v[36:39], v[44:47], v[100:103], 0
    ds_read2_b32 v[48:49], v4 offset0:48 offset1:49
    s_cbranch_vccnz gated_mix__ssm_conv_s4d__mixer_channel_mlp__prompt_kernel_ho12
    s_add_u32 s85, s85, 122880
    buffer_load_dwordx4 v[176:179], v253, s[44:47], s85 offen offset:2048 sc1
    buffer_load_dwordx4 v[180:183], v253, s[44:47], s85 offen offset:3072 sc1
    s_add_u32 s85, s85, 4096
    buffer_load_dwordx4 v[184:187], v253, s[44:47], s85 offen offset:0 sc1
gated_mix__ssm_conv_s4d__mixer_channel_mlp__prompt_kernel_ho12:
    s_waitcnt lgkmcnt(7)
    v_mfma_f32_16x16x32_bf16 v[32:35], v[44:47], v[96:99], 0
    ds_read2_b32 v[50:51], v4 offset0:50 offset1:51
    s_waitcnt lgkmcnt(7)
    v_mfma_f32_16x16x32_bf16 v[28:31], v[44:47], v[92:95], 0
    ds_read2_b32 v[52:53], v5 offset0:176 offset1:177
    s_waitcnt lgkmcnt(7)
    v_mfma_f32_16x16x32_bf16 v[24:27], v[44:47], v[88:91], 0
    ds_read2_b32 v[54:55], v5 offset0:178 offset1:179
    s_waitcnt lgkmcnt(7)
    v_mfma_f32_16x16x32_bf16 v[20:23], v[44:47], v[84:87], 0
    ds_read2_b32 v[56:57], v5 offset0:48 offset1:49
    s_waitcnt lgkmcnt(7)
    v_mfma_f32_16x16x32_bf16 v[16:19], v[44:47], v[80:83], 0
    ds_read2_b32 v[58:59], v5 offset0:50 offset1:51
    s_waitcnt lgkmcnt(7)
    v_mfma_f32_16x16x32_bf16 v[12:15], v[44:47], v[76:79], 0
    ds_read2_b32 v[60:61], v6 offset0:176 offset1:177
    s_waitcnt lgkmcnt(5)
    v_mfma_f32_16x16x32_bf16 v[40:43], v[48:51], v[100:103], v[40:43]
    ds_read_b128 v[100:103], v3 offset:3200
    v_mfma_f32_16x16x32_bf16 v[36:39], v[48:51], v[96:99], v[36:39]
    ds_read2_b32 v[62:63], v6 offset0:178 offset1:179
    v_mfma_f32_16x16x32_bf16 v[32:35], v[48:51], v[92:95], v[32:35]
    ds_read2_b32 v[64:65], v6 offset0:48 offset1:49
    v_mfma_f32_16x16x32_bf16 v[28:31], v[48:51], v[88:91], v[28:31]
    ds_read2_b32 v[66:67], v6 offset0:50 offset1:51
    v_mfma_f32_16x16x32_bf16 v[24:27], v[48:51], v[84:87], v[24:27]
    ds_read2_b32 v[68:69], v7 offset0:176 offset1:177
    v_mfma_f32_16x16x32_bf16 v[20:23], v[48:51], v[80:83], v[20:23]
    ds_read2_b32 v[70:71], v7 offset0:178 offset1:179
    s_cbranch_vccnz gated_mix__ssm_conv_s4d__mixer_channel_mlp__prompt_kernel_ho13
    s_add_u32 s85, s85, 36864
    buffer_load_dwordx4 v[188:191], v253, s[44:47], s85 offen offset:0 sc1
    buffer_load_dwordx4 v[192:195], v253, s[44:47], s85 offen offset:1024 sc1
    buffer_load_dwordx4 v[196:199], v253, s[44:47], s85 offen offset:2048 sc1
gated_mix__ssm_conv_s4d__mixer_channel_mlp__prompt_kernel_ho13:
    v_mfma_f32_16x16x32_bf16 v[16:19], v[48:51], v[76:79], v[16:19]
    ds_read2_b32 v[72:73], v7 offset0:48 offset1:49
    s_waitcnt lgkmcnt(10)
    v_mfma_f32_16x16x32_bf16 v[40:43], v[52:55], v[96:99], v[40:43]
    ds_read_b128 v[96:99], v3 offset:2688
    v_mfma_f32_16x16x32_bf16 v[36:39], v[52:55], v[92:95], v[36:39]
    ds_read2_b32 v[74:75], v7 offset0:50 offset1:51
    v_mfma_f32_16x16x32_bf16 v[32:35], v[52:55], v[88:91], v[32:35]
    ds_read2_b32 v[44:45], v4 offset0:160 offset1:161
    v_mfma_f32_16x16x32_bf16 v[28:31], v[52:55], v[84:87], v[28:31]
    ds_read2_b32 v[46:47], v4 offset0:162 offset1:163
    v_mfma_f32_16x16x32_bf16 v[24:27], v[52:55], v[80:83], v[24:27]
    ds_read2_b32 v[48:49], v4 offset0:32 offset1:33
    v_mfma_f32_16x16x32_bf16 v[20:23], v[52:55], v[76:79], v[20:23]
    ds_read2_b32 v[50:51], v4 offset0:34 offset1:35
    s_waitcnt lgkmcnt(14)
    v_mfma_f32_16x16x32_bf16 v[40:43], v[56:59], v[92:95], v[40:43]
    ds_read_b128 v[92:95], v3 offset:2176
    v_mfma_f32_16x16x32_bf16 v[36:39], v[56:59], v[88:91], v[36:39]
    ds_read2_b32 v[52:53], v5 offset0:160 offset1:161
    v_mfma_f32_16x16x32_bf16 v[32:35], v[56:59], v[84:87], v[32:35]
    ds_read2_b32 v[54:55], v5 offset0:162 offset1:163
    v_mfma_f32_16x16x32_bf16 v[28:31], v[56:59], v[80:83], v[28:31]
    v_mfma_f32_16x16x32_bf16 v[24:27], v[56:59], v[76:79], v[24:27]
    ds_read2_b32 v[56:57], v5 offset0:32 offset1:33
    s_cbranch_vccnz gated_mix__ssm_conv_s4d__mixer_channel_mlp__prompt_kernel_ho14
    buffer_load_dwordx4 v[200:203], v253, s[44:47], s85 offen offset:3072 sc1
    s_add_u32 s85, s85, 4096
    buffer_load_dwordx4 v[204:207], v253, s[44:47], s85 offen offset:0 sc1
    s_add_u32 s85, s85, 36864
    buffer_load_dwordx4 v[208:211], v253, s[44:47], s85 offen offset:0 sc1
gated_mix__ssm_conv_s4d__mixer_channel_mlp__prompt_kernel_ho14:
    s_waitcnt lgkmcnt(15)
    v_mfma_f32_16x16x32_bf16 v[40:43], v[60:63], v[88:91], v[40:43]
    ds_read_b128 v[88:91], v3 offset:1664
    v_mfma_f32_16x16x32_bf16 v[36:39], v[60:63], v[84:87], v[36:39]
    ds_read2_b32 v[58:59], v5 offset0:34 offset1:35
    v_mfma_f32_16x16x32_bf16 v[32:35], v[60:63], v[80:83], v[32:35]
    v_mfma_f32_16x16x32_bf16 v[28:31], v[60:63], v[76:79], v[28:31]
    ds_read2_b32 v[60:61], v6 offset0:160 offset1:161
    s_waitcnt lgkmcnt(15)
    v_mfma_f32_16x16x32_bf16 v[40:43], v[64:67], v[84:87], v[40:43]
    ds_read_b128 v[84:87], v3 offset:1152
    v_mfma_f32_16x16x32_bf16 v[36:39], v[64:67], v[80:83], v[36:39]
    ds_read2_b32 v[62:63], v6 offset0:162 offset1:163
    v_mfma_f32_16x16x32_bf16 v[32:35], v[64:67], v[76:79], v[32:35]
    ds_read2_b32 v[64:65], v6 offset0:32 offset1:33
    s_waitcnt lgkmcnt(15)
    v_mfma_f32_16x16x32_bf16 v[40:43], v[68:71], v[80:83], v[40:43]
    ds_read_b128 v[80:83], v3 offset:640
    v_mfma_f32_16x16x32_bf16 v[36:39], v[68:71], v[76:79], v[36:39]
    ds_read2_b32 v[66:67], v6 offset0:34 offset1:35
    s_waitcnt lgkmcnt(15)
    v_mfma_f32_16x16x32_bf16 v[40:43], v[72:75], v[76:79], v[40:43]
    ds_read_b128 v[76:79], v3 offset:128
    s_waitcnt lgkmcnt(15)
    v_mfma_f32_16x16x32_bf16 v[40:43], v[44:47], v[104:107], v[40:43]
    ds_read_b128 v[104:107], v3 offset:3648
    v_mfma_f32_16x16x32_bf16 v[36:39], v[44:47], v[100:103], v[36:39]
    ds_read2_b32 v[68:69], v7 offset0:160 offset1:161
    s_cbranch_vccnz gated_mix__ssm_conv_s4d__mixer_channel_mlp__prompt_kernel_ho15
    buffer_load_dwordx4 v[212:215], v253, s[44:47], s85 offen offset:1024 sc1
    buffer_load_dwordx4 v[216:219], v253, s[44:47], s85 offen offset:2048 sc1
    buffer_load_dwordx4 v[220:223], v253, s[44:47], s85 offen offset:3072 sc1
gated_mix__ssm_conv_s4d__mixer_channel_mlp__prompt_kernel_ho15:
    v_mfma_f32_16x16x32_bf16 v[32:35], v[44:47], v[96:99], v[32:35]
    ds_read2_b32 v[70:71], v7 offset0:162 offset1:163
    s_waitcnt lgkmcnt(15)
    v_mfma_f32_16x16x32_bf16 v[28:31], v[44:47], v[92:95], v[28:31]
    ds_read2_b32 v[72:73], v7 offset0:32 offset1:33
    s_waitcnt lgkmcnt(12)
    v_mfma_f32_16x16x32_bf16 v[24:27], v[44:47], v[88:91], v[24:27]
    ds_read2_b32 v[74:75], v7 offset0:34 offset1:35
    s_waitcnt lgkmcnt(10)
    v_mfma_f32_16x16x32_bf16 v[20:23], v[44:47], v[84:87], v[20:23]
    s_waitcnt lgkmcnt(7)
    v_mfma_f32_16x16x32_bf16 v[16:19], v[44:47], v[80:83], v[16:19]
    s_waitcnt lgkmcnt(5)
    v_mfma_f32_16x16x32_bf16 v[12:15], v[44:47], v[76:79], v[12:15]
    ds_read2_b32 v[44:45], v4 offset0:144 offset1:145
    v_mfma_f32_16x16x32_bf16 v[40:43], v[48:51], v[100:103], v[40:43]
    ds_read_b128 v[100:103], v3 offset:3136
    v_mfma_f32_16x16x32_bf16 v[36:39], v[48:51], v[96:99], v[36:39]
    ds_read2_b32 v[46:47], v4 offset0:146 offset1:147
    v_mfma_f32_16x16x32_bf16 v[32:35], v[48:51], v[92:95], v[32:35]
    v_mfma_f32_16x16x32_bf16 v[28:31], v[48:51], v[88:91], v[28:31]
    v_mfma_f32_16x16x32_bf16 v[24:27], v[48:51], v[84:87], v[24:27]
    v_mfma_f32_16x16x32_bf16 v[20:23], v[48:51], v[80:83], v[20:23]
    s_cbranch_vccnz gated_mix__ssm_conv_s4d__mixer_channel_mlp__prompt_kernel_ho16
    s_add_u32 s85, s85, 4096
    buffer_load_dwordx4 v[224:227], v253, s[44:47], s85 offen offset:0 sc1
    s_add_u32 s85, s85, 36864
    buffer_load_dwordx4 v[228:231], v254, s[44:47], s85 offen offset:0 sc1
    buffer_load_dwordx4 v[232:235], v254, s[44:47], s85 offen offset:1024 sc1
gated_mix__ssm_conv_s4d__mixer_channel_mlp__prompt_kernel_ho16:
    v_mfma_f32_16x16x32_bf16 v[16:19], v[48:51], v[76:79], v[16:19]
    ds_read2_b32 v[48:49], v4 offset0:16 offset1:17
    v_mfma_f32_16x16x32_bf16 v[40:43], v[52:55], v[96:99], v[40:43]
    ds_read_b128 v[96:99], v3 offset:2624
    v_mfma_f32_16x16x32_bf16 v[36:39], v[52:55], v[92:95], v[36:39]
    ds_read2_b32 v[50:51], v4 offset0:18 offset1:19
    v_mfma_f32_16x16x32_bf16 v[32:35], v[52:55], v[88:91], v[32:35]
    v_mfma_f32_16x16x32_bf16 v[28:31], v[52:55], v[84:87], v[28:31]
    v_mfma_f32_16x16x32_bf16 v[24:27], v[52:55], v[80:83], v[24:27]
    v_mfma_f32_16x16x32_bf16 v[20:23], v[52:55], v[76:79], v[20:23]
    ds_read2_b32 v[52:53], v5 offset0:144 offset1:145
    v_mfma_f32_16x16x32_bf16 v[40:43], v[56:59], v[92:95], v[40:43]
    ds_read_b128 v[92:95], v3 offset:2112
    v_mfma_f32_16x16x32_bf16 v[36:39], v[56:59], v[88:91], v[36:39]
    ds_read2_b32 v[54:55], v5 offset0:146 offset1:147
    v_mfma_f32_16x16x32_bf16 v[32:35], v[56:59], v[84:87], v[32:35]
    v_mfma_f32_16x16x32_bf16 v[28:31], v[56:59], v[80:83], v[28:31]
    v_mfma_f32_16x16x32_bf16 v[24:27], v[56:59], v[76:79], v[24:27]
    ds_read2_b32 v[56:57], v5 offset0:16 offset1:17
    s_cbranch_vccnz gated_mix__ssm_conv_s4d__mixer_channel_mlp__prompt_kernel_ho17
    buffer_load_dwordx4 v[236:239], v254, s[44:47], s85 offen offset:2048 sc1
    buffer_load_dwordx4 v[240:243], v254, s[44:47], s85 offen offset:3072 sc1
    s_add_u32 s85, s85, 4096
    buffer_load_dwordx4 v[244:247], v254, s[44:47], s85 offen offset:0 sc1
gated_mix__ssm_conv_s4d__mixer_channel_mlp__prompt_kernel_ho17:
    v_mfma_f32_16x16x32_bf16 v[40:43], v[60:63], v[88:91], v[40:43]
    ds_read_b128 v[88:91], v3 offset:1600
    v_mfma_f32_16x16x32_bf16 v[36:39], v[60:63], v[84:87], v[36:39]
    ds_read2_b32 v[58:59], v5 offset0:18 offset1:19
    v_mfma_f32_16x16x32_bf16 v[32:35], v[60:63], v[80:83], v[32:35]
    v_mfma_f32_16x16x32_bf16 v[28:31], v[60:63], v[76:79], v[28:31]
    ds_read2_b32 v[60:61], v6 offset0:144 offset1:145
    v_mfma_f32_16x16x32_bf16 v[40:43], v[64:67], v[84:87], v[40:43]
    ds_read_b128 v[84:87], v3 offset:1088
    v_mfma_f32_16x16x32_bf16 v[36:39], v[64:67], v[80:83], v[36:39]
    ds_read2_b32 v[62:63], v6 offset0:146 offset1:147
    v_mfma_f32_16x16x32_bf16 v[32:35], v[64:67], v[76:79], v[32:35]
    ds_read2_b32 v[64:65], v6 offset0:16 offset1:17
    s_waitcnt lgkmcnt(15)
    v_mfma_f32_16x16x32_bf16 v[40:43], v[68:71], v[80:83], v[40:43]
    ds_read_b128 v[80:83], v3 offset:576
    v_mfma_f32_16x16x32_bf16 v[36:39], v[68:71], v[76:79], v[36:39]
    ds_read2_b32 v[66:67], v6 offset0:18 offset1:19
    v_mfma_f32_16x16x32_bf16 v[40:43], v[72:75], v[76:79], v[40:43]
    ds_read_b128 v[76:79], v3 offset:64
    s_waitcnt lgkmcnt(15)
    v_mfma_f32_16x16x32_bf16 v[40:43], v[44:47], v[104:107], v[40:43]
    ds_read_b128 v[104:107], v3 offset:3584
    v_mfma_f32_16x16x32_bf16 v[36:39], v[44:47], v[100:103], v[36:39]
    ds_read2_b32 v[68:69], v7 offset0:144 offset1:145
    s_cbranch_vccnz gated_mix__ssm_conv_s4d__mixer_channel_mlp__prompt_kernel_ho18
    s_add_u32 s85, s85, 4294717440
    buffer_load_dwordx4 v[108:111], v253, s[44:47], s85 offen offset:0 sc1
    buffer_load_dwordx4 v[112:115], v253, s[44:47], s85 offen offset:1024 sc1
    buffer_load_dwordx4 v[116:119], v253, s[44:47], s85 offen offset:2048 sc1
gated_mix__ssm_conv_s4d__mixer_channel_mlp__prompt_kernel_ho18:
    s_waitcnt lgkmcnt(15)
    v_mfma_f32_16x16x32_bf16 v[32:35], v[44:47], v[96:99], v[32:35]
    ds_read2_b32 v[70:71], v7 offset0:146 offset1:147
    s_waitcnt lgkmcnt(14)
    v_mfma_f32_16x16x32_bf16 v[28:31], v[44:47], v[92:95], v[28:31]
    ds_read2_b32 v[72:73], v7 offset0:16 offset1:17
    s_waitcnt lgkmcnt(12)
    v_mfma_f32_16x16x32_bf16 v[24:27], v[44:47], v[88:91], v[24:27]
    ds_read2_b32 v[74:75], v7 offset0:18 offset1:19
    s_waitcnt lgkmcnt(10)
    v_mfma_f32_16x16x32_bf16 v[20:23], v[44:47], v[84:87], v[20:23]
    s_waitcnt lgkmcnt(7)
    v_mfma_f32_16x16x32_bf16 v[16:19], v[44:47], v[80:83], v[16:19]
    s_waitcnt lgkmcnt(5)
    v_mfma_f32_16x16x32_bf16 v[12:15], v[44:47], v[76:79], v[12:15]
    ds_read2_b32 v[44:45], v4 offset0:128 offset1:129
    v_mfma_f32_16x16x32_bf16 v[40:43], v[48:51], v[100:103], v[40:43]
    ds_read_b128 v[100:103], v3 offset:3072
    v_mfma_f32_16x16x32_bf16 v[36:39], v[48:51], v[96:99], v[36:39]
    ds_read2_b32 v[46:47], v4 offset0:130 offset1:131
    v_mfma_f32_16x16x32_bf16 v[32:35], v[48:51], v[92:95], v[32:35]
    v_mfma_f32_16x16x32_bf16 v[28:31], v[48:51], v[88:91], v[28:31]
    v_mfma_f32_16x16x32_bf16 v[24:27], v[48:51], v[84:87], v[24:27]
    v_mfma_f32_16x16x32_bf16 v[20:23], v[48:51], v[80:83], v[20:23]
    s_cbranch_vccnz gated_mix__ssm_conv_s4d__mixer_channel_mlp__prompt_kernel_ho19
    buffer_load_dwordx4 v[120:123], v253, s[44:47], s85 offen offset:3072 sc1
    s_add_u32 s85, s85, 4096
    buffer_load_dwordx4 v[124:127], v253, s[44:47], s85 offen offset:0 sc1
    s_add_u32 s85, s85, 36864
    buffer_load_dwordx4 v[128:131], v253, s[44:47], s85 offen offset:0 sc1
gated_mix__ssm_conv_s4d__mixer_channel_mlp__prompt_kernel_ho19:
    v_mfma_f32_16x16x32_bf16 v[16:19], v[48:51], v[76:79], v[16:19]
    ds_read2_b32 v[48:49], v4 offset0:0 offset1:1
    v_mfma_f32_16x16x32_bf16 v[40:43], v[52:55], v[96:99], v[40:43]
    ds_read_b128 v[96:99], v3 offset:2560
    v_mfma_f32_16x16x32_bf16 v[36:39], v[52:55], v[92:95], v[36:39]
    ds_read2_b32 v[50:51], v4 offset0:2 offset1:3
    v_mfma_f32_16x16x32_bf16 v[32:35], v[52:55], v[88:91], v[32:35]
    v_mfma_f32_16x16x32_bf16 v[28:31], v[52:55], v[84:87], v[28:31]
    v_mfma_f32_16x16x32_bf16 v[24:27], v[52:55], v[80:83], v[24:27]
    v_mfma_f32_16x16x32_bf16 v[20:23], v[52:55], v[76:79], v[20:23]
    ds_read2_b32 v[52:53], v5 offset0:128 offset1:129
    v_mfma_f32_16x16x32_bf16 v[40:43], v[56:59], v[92:95], v[40:43]
    ds_read_b128 v[92:95], v3 offset:2048
    v_mfma_f32_16x16x32_bf16 v[36:39], v[56:59], v[88:91], v[36:39]
    ds_read2_b32 v[54:55], v5 offset0:130 offset1:131
    v_mfma_f32_16x16x32_bf16 v[32:35], v[56:59], v[84:87], v[32:35]
    v_mfma_f32_16x16x32_bf16 v[28:31], v[56:59], v[80:83], v[28:31]
    v_mfma_f32_16x16x32_bf16 v[24:27], v[56:59], v[76:79], v[24:27]
    ds_read2_b32 v[56:57], v5 offset0:0 offset1:1
    s_cbranch_vccnz gated_mix__ssm_conv_s4d__mixer_channel_mlp__prompt_kernel_ho20
    buffer_load_dwordx4 v[132:135], v253, s[44:47], s85 offen offset:1024 sc1
    buffer_load_dwordx4 v[136:139], v253, s[44:47], s85 offen offset:2048 sc1
    buffer_load_dwordx4 v[140:143], v253, s[44:47], s85 offen offset:3072 sc1
gated_mix__ssm_conv_s4d__mixer_channel_mlp__prompt_kernel_ho20:
    v_mfma_f32_16x16x32_bf16 v[40:43], v[60:63], v[88:91], v[40:43]
    ds_read_b128 v[88:91], v3 offset:1536
    v_mfma_f32_16x16x32_bf16 v[36:39], v[60:63], v[84:87], v[36:39]
    ds_read2_b32 v[58:59], v5 offset0:2 offset1:3
    v_mfma_f32_16x16x32_bf16 v[32:35], v[60:63], v[80:83], v[32:35]
    v_mfma_f32_16x16x32_bf16 v[28:31], v[60:63], v[76:79], v[28:31]
    ds_read2_b32 v[60:61], v6 offset0:128 offset1:129
    v_mfma_f32_16x16x32_bf16 v[40:43], v[64:67], v[84:87], v[40:43]
    ds_read_b128 v[84:87], v3 offset:1024
    v_mfma_f32_16x16x32_bf16 v[36:39], v[64:67], v[80:83], v[36:39]
    ds_read2_b32 v[62:63], v6 offset0:130 offset1:131
    v_mfma_f32_16x16x32_bf16 v[32:35], v[64:67], v[76:79], v[32:35]
    ds_read2_b32 v[64:65], v6 offset0:0 offset1:1
    s_waitcnt lgkmcnt(15)
    v_mfma_f32_16x16x32_bf16 v[40:43], v[68:71], v[80:83], v[40:43]
    ds_read_b128 v[80:83], v3 offset:512
    v_mfma_f32_16x16x32_bf16 v[36:39], v[68:71], v[76:79], v[36:39]
    ds_read2_b32 v[66:67], v6 offset0:2 offset1:3
    v_mfma_f32_16x16x32_bf16 v[40:43], v[72:75], v[76:79], v[40:43]
    ds_read_b128 v[76:79], v3 offset:0
    s_waitcnt lgkmcnt(15)
    v_mfma_f32_16x16x32_bf16 v[40:43], v[44:47], v[104:107], v[40:43]
    ds_read2_b32 v[68:69], v7 offset0:128 offset1:129
    v_mfma_f32_16x16x32_bf16 v[36:39], v[44:47], v[100:103], v[36:39]
    ds_read2_b32 v[70:71], v7 offset0:130 offset1:131
    s_cbranch_vccnz gated_mix__ssm_conv_s4d__mixer_channel_mlp__prompt_kernel_ho21
    s_add_u32 s85, s85, 4096
    buffer_load_dwordx4 v[144:147], v253, s[44:47], s85 offen offset:0 sc1
    s_add_u32 s85, s85, 36864
    buffer_load_dwordx4 v[148:151], v253, s[44:47], s85 offen offset:0 sc1
    buffer_load_dwordx4 v[152:155], v253, s[44:47], s85 offen offset:1024 sc1
gated_mix__ssm_conv_s4d__mixer_channel_mlp__prompt_kernel_ho21:
    s_waitcnt lgkmcnt(15)
    v_mfma_f32_16x16x32_bf16 v[32:35], v[44:47], v[96:99], v[32:35]
    ds_read2_b32 v[72:73], v7 offset0:0 offset1:1
    s_waitcnt lgkmcnt(14)
    v_mfma_f32_16x16x32_bf16 v[28:31], v[44:47], v[92:95], v[28:31]
    ds_read2_b32 v[74:75], v7 offset0:2 offset1:3
    s_waitcnt lgkmcnt(12)
    v_mfma_f32_16x16x32_bf16 v[24:27], v[44:47], v[88:91], v[24:27]
    s_waitcnt lgkmcnt(9)
    v_mfma_f32_16x16x32_bf16 v[20:23], v[44:47], v[84:87], v[20:23]
    s_waitcnt lgkmcnt(6)
    v_mfma_f32_16x16x32_bf16 v[16:19], v[44:47], v[80:83], v[16:19]
    s_waitcnt lgkmcnt(4)
    v_mfma_f32_16x16x32_bf16 v[12:15], v[44:47], v[76:79], v[12:15]
    v_mfma_f32_16x16x32_bf16 v[40:43], v[48:51], v[100:103], v[40:43]
    v_mfma_f32_16x16x32_bf16 v[36:39], v[48:51], v[96:99], v[36:39]
    v_mfma_f32_16x16x32_bf16 v[32:35], v[48:51], v[92:95], v[32:35]
    v_mfma_f32_16x16x32_bf16 v[28:31], v[48:51], v[88:91], v[28:31]
    v_mfma_f32_16x16x32_bf16 v[24:27], v[48:51], v[84:87], v[24:27]
    v_mfma_f32_16x16x32_bf16 v[20:23], v[48:51], v[80:83], v[20:23]
    s_cbranch_vccnz gated_mix__ssm_conv_s4d__mixer_channel_mlp__prompt_kernel_ho22
    buffer_load_dwordx4 v[156:159], v253, s[44:47], s85 offen offset:2048 sc1
    buffer_load_dwordx4 v[160:163], v253, s[44:47], s85 offen offset:3072 sc1
    s_add_u32 s85, s85, 4096
    buffer_load_dwordx4 v[164:167], v253, s[44:47], s85 offen offset:0 sc1
gated_mix__ssm_conv_s4d__mixer_channel_mlp__prompt_kernel_ho22:
    v_mfma_f32_16x16x32_bf16 v[16:19], v[48:51], v[76:79], v[16:19]
    v_mfma_f32_16x16x32_bf16 v[40:43], v[52:55], v[96:99], v[40:43]
    v_mfma_f32_16x16x32_bf16 v[36:39], v[52:55], v[92:95], v[36:39]
    v_mfma_f32_16x16x32_bf16 v[32:35], v[52:55], v[88:91], v[32:35]
    v_mfma_f32_16x16x32_bf16 v[28:31], v[52:55], v[84:87], v[28:31]
    v_mfma_f32_16x16x32_bf16 v[24:27], v[52:55], v[80:83], v[24:27]
    v_mfma_f32_16x16x32_bf16 v[20:23], v[52:55], v[76:79], v[20:23]
    v_mfma_f32_16x16x32_bf16 v[40:43], v[56:59], v[92:95], v[40:43]
    v_mfma_f32_16x16x32_bf16 v[36:39], v[56:59], v[88:91], v[36:39]
    v_mfma_f32_16x16x32_bf16 v[32:35], v[56:59], v[84:87], v[32:35]
    v_mfma_f32_16x16x32_bf16 v[28:31], v[56:59], v[80:83], v[28:31]
    v_mfma_f32_16x16x32_bf16 v[24:27], v[56:59], v[76:79], v[24:27]
    v_mfma_f32_16x16x32_bf16 v[40:43], v[60:63], v[88:91], v[40:43]
    v_mfma_f32_16x16x32_bf16 v[36:39], v[60:63], v[84:87], v[36:39]
    v_mfma_f32_16x16x32_bf16 v[32:35], v[60:63], v[80:83], v[32:35]
    v_mfma_f32_16x16x32_bf16 v[28:31], v[60:63], v[76:79], v[28:31]
    v_mfma_f32_16x16x32_bf16 v[40:43], v[64:67], v[84:87], v[40:43]
    v_mfma_f32_16x16x32_bf16 v[36:39], v[64:67], v[80:83], v[36:39]
    v_mfma_f32_16x16x32_bf16 v[32:35], v[64:67], v[76:79], v[32:35]
    s_waitcnt lgkmcnt(2)
    v_mfma_f32_16x16x32_bf16 v[40:43], v[68:71], v[80:83], v[40:43]
    v_mfma_f32_16x16x32_bf16 v[36:39], v[68:71], v[76:79], v[36:39]
    s_waitcnt lgkmcnt(0)
    v_mfma_f32_16x16x32_bf16 v[40:43], v[72:75], v[76:79], v[40:43]
    s_cmp_eq_u32 s75, 0
    s_nop 6
    s_cbranch_scc1 gated_mix__ssm_conv_s4d__mixer_channel_mlp__prompt_kernel_cx23
    ds_write_b128 v9, v[12:15] offset:0
    ds_write_b128 v9, v[16:19] offset:1024
    ds_write_b128 v9, v[20:23] offset:2048
    ds_write_b128 v9, v[24:27] offset:3072
    s_branch gated_mix__ssm_conv_s4d__mixer_channel_mlp__prompt_kernel_cy24
gated_mix__ssm_conv_s4d__mixer_channel_mlp__prompt_kernel_cx23:
    ds_write_b128 v9, v[28:31] offset:0
    ds_write_b128 v9, v[32:35] offset:1024
    ds_write_b128 v9, v[36:39] offset:2048
    ds_write_b128 v9, v[40:43] offset:3072
gated_mix__ssm_conv_s4d__mixer_channel_mlp__prompt_kernel_cy24:
    s_cbranch_vccz gated_mix__ssm_conv_s4d__mixer_channel_mlp__prompt_kernel_f5
    s_add_u32 s85, s85, 45056
    buffer_load_dwordx4 v[144:147], v253, s[44:47], s85 offen offset:0 sc1
    s_add_u32 s85, s85, 36864
    buffer_load_dwordx4 v[148:151], v253, s[44:47], s85 offen offset:0 sc1
    buffer_load_dwordx4 v[152:155], v253, s[44:47], s85 offen offset:1024 sc1
    buffer_load_dwordx4 v[156:159], v253, s[44:47], s85 offen offset:2048 sc1
gated_mix__ssm_conv_s4d__mixer_channel_mlp__prompt_kernel_f5:
    s_waitcnt lgkmcnt(0)
    s_barrier
    s_cmp_eq_u32 s75, 0
    s_cbranch_scc1 gated_mix__ssm_conv_s4d__mixer_channel_mlp__prompt_kernel_cx25
    ds_read_b128 v[12:15], v10 offset:0
    ds_read_b128 v[16:19], v10 offset:1024
    ds_read_b128 v[20:23], v10 offset:2048
    ds_read_b128 v[24:27], v10 offset:3072
    s_branch gated_mix__ssm_conv_s4d__mixer_channel_mlp__prompt_kernel_cy26
gated_mix__ssm_conv_s4d__mixer_channel_mlp__prompt_kernel_cx25:
    ds_read_b128 v[28:31], v10 offset:0
    ds_read_b128 v[32:35], v10 offset:1024
    ds_read_b128 v[36:39], v10 offset:2048
    ds_read_b128 v[40:43], v10 offset:3072
gated_mix__ssm_conv_s4d__mixer_channel_mlp__prompt_kernel_cy26:
    s_waitcnt lgkmcnt(2)
    v_pk_add_f32 v[12:13], v[12:13], v[28:29]
    v_pk_add_f32 v[14:15], v[14:15], v[30:31]
    v_pk_add_f32 v[16:17], v[16:17], v[32:33]
    v_pk_add_f32 v[18:19], v[18:19], v[34:35]
    v_cvt_pk_bf16_f32 v44, v12, v13
    v_cvt_pk_bf16_f32 v45, v14, v15
    v_cvt_pk_bf16_f32 v46, v16, v17
    v_cvt_pk_bf16_f32 v47, v18, v19
    buffer_store_dwordx4 v[44:47], v8, s[44:47], s71 offen offset:0 sc1
    s_waitcnt lgkmcnt(0)
    v_pk_add_f32 v[20:21], v[20:21], v[36:37]
    v_pk_add_f32 v[22:23], v[22:23], v[38:39]
    v_pk_add_f32 v[24:25], v[24:25], v[40:41]
    v_pk_add_f32 v[26:27], v[26:27], v[42:43]
    v_cvt_pk_bf16_f32 v48, v20, v21
    v_cvt_pk_bf16_f32 v49, v22, v23
    v_cvt_pk_bf16_f32 v50, v24, v25
    v_cvt_pk_bf16_f32 v51, v26, v27
    buffer_store_dwordx4 v[48:51], v8, s[44:47], s71 offen offset:1024 sc1
    s_cbranch_vccnz gated_mix__ssm_conv_s4d__mixer_channel_mlp__prompt_kernel_f4
    v_add_u32 v4, 131072, v4
    v_add_u32 v5, 131072, v5
    v_add_u32 v6, 131072, v6
    v_add_u32 v7, 131072, v7
    s_mul_i32 s66, s3, 4096
    s_add_u32 s66, s66, 0
    v_lshl_add_u32 v9, v0, 4, s66
    s_xor_b32 s66, s3, 1
    s_mul_i32 s66, s66, 4096
    s_add_u32 s66, s66, 0
    v_lshl_add_u32 v10, v0, 4, s66
    s_waitcnt vmcnt(33)
    ds_write_b128 v1, v[168:171]
    ds_write_b128 v1, v[172:175] offset:512
    ds_write_b32 v2, v11
    s_lshl1_add_u32 s71, s60, s74
    s_mul_i32 s71, s71, 4096
    s_lshl_b32 s72, s75, 11
    s_add_u32 s71, s71, s72
    s_add_u32 s71, s71, 4194304
    s_branch gated_mix__ssm_conv_s4d__mixer_channel_mlp__prompt_kernel_hc
gated_mix__ssm_conv_s4d__mixer_channel_mlp__prompt_kernel_c0:
    s_cmp_ge_u32 s57, 28
    s_cbranch_scc1 gated_mix__ssm_conv_s4d__mixer_channel_mlp__prompt_kernel_fc
    s_lshl_b32 s66, s3, 6
    v_add_u32 v161, s66, v0
    v_mul_u32_u24 v172, 6554, v161
    v_mul_u32_u24 v173, 3277, v161
    v_lshrrev_b32 v172, 16, v172
    v_lshrrev_b32 v173, 16, v173
    v_mul_u32_u24 v172, 1120, v172
    v_mul_u32_u24 v173, 960, v173
    v_lshl_add_u32 v162, v161, 4, v172
    v_lshl_add_u32 v165, v161, 4, v173
    v_add_u32 v161, 256, v161
    v_mul_u32_u24 v172, 6554, v161
    v_mul_u32_u24 v173, 3277, v161
    v_lshrrev_b32 v172, 16, v172
    v_lshrrev_b32 v173, 16, v173
    v_mul_u32_u24 v172, 1120, v172
    v_mul_u32_u24 v173, 960, v173
    v_lshl_add_u32 v163, v161, 4, v172
    v_lshl_add_u32 v166, v161, 4, v173
    v_add_u32 v161, 256, v161
    v_mul_u32_u24 v172, 6554, v161
    v_mul_u32_u24 v173, 3277, v161
    v_lshrrev_b32 v172, 16, v172
    v_lshrrev_b32 v173, 16, v173
    v_mul_u32_u24 v172, 1120, v172
    v_mul_u32_u24 v173, 960, v173
    v_lshl_add_u32 v164, v161, 4, v172
    v_lshl_add_u32 v167, v161, 4, v173
    v_and_b32 v161, 31, v0
    v_lshlrev_b32 v170, 4, v161
    v_lshlrev_b32 v171, 3, v161
    v_lshrrev_b32 v172, 5, v0
    v_mul_u32_u24 v172, 1280, v172
    v_add_u32 v168, v172, v170
    v_add_u32 v169, v172, v171
    s_mul_i32 s68, s61, 81920
    s_mul_i32 s66, s62, 160
    s_add_u32 s68, s68, s66
    s_lshr_b32 s66, s2, 2
    s_mul_i32 s70, s66, 40960
    s_and_b32 s66, s2, 3
    s_mul_i32 s66, s66, 320
    s_add_u32 s70, s70, s66
    s_cmp_ge_u32 s3, 2
    s_cselect_b32 s69, 1073741824, s68
    s_cselect_b32 s71, 1073741824, s70
    s_lshl_b32 s72, s56, 5
    s_add_u32 s72, s72, s57
    s_lshl2_add_u32 s72, s72, s3
    s_mul_i32 s72, s72, 2560
    s_lshl_b32 s73, s3, 10
    s_waitcnt lgkmcnt(0)
    s_mov_b64 s[36:37], s[4:5]
    s_mov_b64 s[40:41], s[20:21]
    s_mov_b64 s[44:45], s[34:35]
    s_mov_b64 s[48:49], s[24:25]
    s_mov_b64 s[52:53], s[30:31]
    s_mov_b64 s[92:93], s[32:33]
    s_add_u32 m0, s73, 131072
    s_nop 0
    buffer_load_dwordx4 v162, s[36:39], s68 offen lds
    s_add_u32 m0, s73, 135168
    s_nop 0
    buffer_load_dwordx4 v163, s[36:39], s68 offen lds
    s_add_u32 m0, s73, 139264
    s_nop 0
    buffer_load_dwordx4 v164, s[36:39], s69 offen lds
    s_add_u32 m0, s73, 143360
    s_nop 0
    buffer_load_dwordx4 v165, s[48:51], s70 offen lds
    s_add_u32 m0, s73, 147456
    s_nop 0
    buffer_load_dwordx4 v166, s[48:51], s70 offen lds
    s_add_u32 m0, s73, 151552
    s_nop 0
    buffer_load_dwordx4 v167, s[48:51], s71 offen lds
    buffer_load_dwordx4 v[176:179], v168, s[36:39], s72 offen
    buffer_load_dwordx4 v[180:183], v168, s[36:39], s72 offen offset:512
    buffer_load_dwordx2 v[184:185], v169, s[36:39], s72 offen offset:1024
    global_load_dwordx4 v[188:191], v170, s[28:29]
    global_load_dwordx4 v[192:195], v170, s[28:29] offset:512
    global_load_dwordx2 v[196:197], v171, s[28:29] offset:1024
    v_cmp_gt_u32 s[90:91], 8, v0
    v_mov_b32 v252, 1073741824
    v_lshlrev_b32 v251, 8, v0
    v_cndmask_b32 v251, v252, v251, s[90:91]
    v_mov_b32 v252, 1
    v_lshlrev_b32 v253, 4, v0
    s_cmp_ge_u32 s101, 6
    s_cselect_b32 s66, 1073741824, 0
    v_add_u32 v254, s66, v253
    s_mul_i32 s85, s62, 54
    s_add_u32 s85, s85, s101
    s_mul_i32 s85, s85, 5120
    s_add_u32 s85, s85, 7340032
    s_mul_i32 s99, s61, 8
    s_add_u32 s99, s99, 512
    s_and_b32 s89, s62, 7
    s_add_u32 s99, s99, s89
    s_lshl_b32 s99, s99, 8
    v_and_b32 v48, 31, v0
    v_lshrrev_b32 v49, 5, v0
    v_bfe_u32 v50, v0, 1, 3
    v_xor_b32 v50, v50, v49
    s_and_b32 s66, s3, 1
    s_lshl_b32 s66, s66, 13
    v_lshl_add_u32 v51, v48, 7, s66
    v_xor_b32 v52, 0, v50
    v_lshl_add_u32 v2, v52, 4, v51
    v_add_u32 v6, 0x10000, v2
    v_xor_b32 v52, 2, v50
    v_lshl_add_u32 v3, v52, 4, v51
    v_add_u32 v7, 0x10000, v3
    v_xor_b32 v52, 4, v50
    v_lshl_add_u32 v4, v52, 4, v51
    v_add_u32 v8, 0x10000, v4
    v_xor_b32 v52, 6, v50
    v_lshl_add_u32 v5, v52, 4, v51
    v_add_u32 v9, 0x10000, v5
    v_bfe_u32 v50, v0, 2, 2
    v_lshl_add_u32 v51, v49, 3, v50
    v_lshlrev_b32 v51, 8, v51
    s_and_b32 s66, s3, 2
    v_xor_b32 v50, s66, v50
    v_lshl_add_u32 v51, v50, 6, v51
    v_and_b32 v50, 16, v0
    v_lshl_add_u32 v51, v50, 1, v51
    v_and_b32 v50, 3, v0
    v_lshl_add_u32 v51, v50, 3, v51
    v_add_u32 v10, 16384, v51
    v_xor_b32 v11, 64, v10
    v_add_u32 v12, 0x10000, v10
    v_add_u32 v13, 0x10000, v11
    s_and_b32 s66, s3, 1
    s_lshl_b32 s66, s66, 6
    v_xor_b32 v10, s66, v10
    v_xor_b32 v11, s66, v11
    v_xor_b32 v12, s66, v12
    v_xor_b32 v13, s66, v13
    v_and_b32 v52, 31, v0
    v_cmp_eq_u32 vcc, 0, v52
    v_cmp_eq_u32 s[66:67], 20, v52
    v_mov_b32 v52, s63
    s_or_b64 vcc, vcc, s[66:67]
    v_cndmask_b32 v48, 0, v52, vcc
    v_cndmask_b32 v49, 0, v52, vcc
    v_cndmask_b32 v50, 0, v52, vcc
    v_cndmask_b32 v51, 0, v52, vcc
    v_and_b32 v58, 31, v0
    s_lshr_b32 s66, s3, 1
    s_lshl1_add_u32 s66, s59, s66
    s_min_u32 s67, s66, 26
    s_lshl_b32 s67, s67, 7
    s_and_b32 s81, s3, 1
    s_lshl_b32 s79, s81, 6
    s_add_u32 s67, s67, s79
    v_lshl_add_u32 v14, v58, 1, s67
    v_xor_b32 v15, 64, v14
    global_load_ushort v56, v14, s[22:23]
    global_load_ushort v57, v15, s[22:23]
    v_lshlrev_b32 v58, 5, v58
    s_lshl_b32 s79, s81, 10
    s_lshl1_add_u32 s81, s58, s81
    s_lshl_b32 s82, s81, 11
    s_add_u32 s82, s82, 65536
    s_mul_i32 s83, s81, 221184
    s_lshl_b32 s67, s66, 11
    s_add_u32 s83, s83, s67
    s_add_u32 s83, s83, 10485760
    s_cmp_eq_u32 s66, 27
    s_cselect_b32 s83, 1073741824, s83
    s_add_u32 s84, s83, 110592
    v_bfe_u32 v59, v0, 4, 1
    v_mul_u32_u24 v59, 55296, v59
    v_lshrrev_b32 v62, 5, v0
    v_lshl_add_u32 v59, v62, 8, v59
    v_and_b32 v62, 15, v0
    v_lshl_add_u32 v59, v62, 4, v59
    v_add_u32 v59, s79, v59
    v_xor_b32 v62, 1024, v59
    s_lshl_b32 s66, s3, 8
    s_add_u32 s66, s66, 162816
    v_lshl_add_u32 v14, v0, 2, s66
    v_xor_b32 v15, 256, v14
    v_lshrrev_b32 v168, 4, v0
    v_bfe_u32 v169, v0, 2, 2
    v_and_b32 v170, 3, v0
    v_lshl_add_u32 v171, v168, 3, v169
    v_mul_u32_u24 v171, 160, v171
    v_lshl_add_u32 v171, v170, 3, v171
    s_and_b32 s66, s3, 1
    s_mul_i32 s67, s66, 5120
    s_lshr_b32 s74, s3, 1
    s_lshl_b32 s75, s74, 5
    s_add_u32 s67, s67, s75
    s_add_u32 s67, s67, 131072
    v_add_u32 v162, s67, v171
    v_lshrrev_b32 v171, 5, v0
    v_lshl_add_u32 v171, v171, 4, v169
    v_and_b32 v172, 16, v0
    v_lshrrev_b32 v172, 2, v172
    v_add_u32 v171, v171, v172
    v_mul_u32_u24 v171, 320, v171
    s_lshl_b32 s67, s74, 6
    s_lshl3_add_u32 s67, s66, s67
    s_add_u32 s67, s67, 143360
    v_lshl_add_u32 v163, v170, 4, v171
    v_add_u32 v163, s67, v163
    s_mul_i32 s67, s66, 160
    s_add_u32 s67, s67, 143488
    v_lshl_add_u32 v164, v170, 3, v171
    v_add_u32 v164, s67, v164
    v_bfe_u32 v169, v0, 1, 3
    v_mul_u32_u24 v169, 8192, v169
    v_lshl_add_u32 v169, v168, 4, v169
    v_and_b32 v170, 1, v0
    v_lshl_add_u32 v165, v170, 6, v169
    v_lshlrev_b32 v166, 4, v0
    v_and_b32 v167, 32, v0
    v_and_b32 v168, 31, v0
    v_cmp_eq_u32 vcc, 16, v168
    v_mov_b32 v168, 1073741824
    s_nop 0
    v_cndmask_b32 v167, v168, v167, vcc
    s_mul_i32 s68, s62, 5
    s_add_u32 s68, s68, s74
    s_mul_i32 s68, s68, 65536
    s_lshl1_add_u32 s67, s61, s66
    s_lshl_b32 s67, s67, 7
    s_add_u32 s68, s68, s67
    s_add_u32 s68, s68, 1048576
    s_add_u32 s69, s68, 131072
    s_add_u32 s70, s68, 262144
    s_and_b32 s67, s2, 3
    s_mul_i32 s67, s67, 108
    s_lshr_b32 s71, s2, 2
    s_add_u32 s67, s67, s71
    s_mul_i32 s67, s67, 5120
    s_add_u32 s67, s67, 7340032
    s_cmp_ge_u32 s2, 216
    s_cselect_b32 s67, 1073741824, s67
    s_add_u32 s71, s67, s73
    s_add_u32 s72, s71, 276480
    s_mul_i32 s75, s66, 276480
    s_add_u32 s75, s75, s67
    s_add_u32 s75, s75, 4096
    s_cmp_ge_u32 s3, 2
    s_cselect_b32 s70, 1073741824, s70
    s_cselect_b32 s75, 1073741824, s75
    s_lshl_b32 s76, s56, 5
    s_add_u32 s76, s76, s57
    s_lshl2_add_u32 s76, s76, s3
    s_lshl_b32 s76, s76, 6
    s_add_u32 s76, s76, 65536
    s_cmp_eq_u32 s3, 0
    s_cselect_b32 s89, 1, 0
    v_cmp_gt_u32 s[90:91], s89, v0
    v_lshlrev_b32 v248, 8, v0
    v_mov_b32 v249, 1073741824
    v_cndmask_b32 v248, v249, v248, s[90:91]
    v_cndmask_b32 v249, 0, 1, s[90:91]
    s_mul_i32 s98, s56, 8
    s_add_u32 s98, s98, 0
    s_lshl_b32 s98, s98, 8
    s_cmp_eq_u32 s3, 0
    s_cselect_b32 s98, s98, 1073741824
    s_waitcnt vmcnt(2)
    s_barrier
    ds_read_b64_tr_b16 v[200:201], v162 offset:0
    ds_read_b64_tr_b16 v[202:203], v162 offset:640
    ds_read_b64_tr_b16 v[204:205], v162 offset:64
    ds_read_b64_tr_b16 v[206:207], v162 offset:704
    ds_read_b64_tr_b16 v[208:209], v162 offset:128
    ds_read_b64_tr_b16 v[210:211], v162 offset:768
    ds_read_b64_tr_b16 v[212:213], v163 offset:0
    ds_read_b64_tr_b16 v[214:215], v163 offset:2560
    ds_read_b64_tr_b16 v[216:217], v163 offset:160
    ds_read_b64_tr_b16 v[218:219], v163 offset:2720
    ds_read_b64_tr_b16 v[220:221], v164 offset:0
    ds_read_b64_tr_b16 v[222:223], v164 offset:2560
    v_dot2_f32_bf16 v172, v176, s63, 0
    v_dot2_f32_bf16 v173, v176, v176, 0
    v_dot2_f32_bf16 v174, v176, v188, 0
    v_dot2_f32_bf16 v172, v177, s63, v172
    v_dot2_f32_bf16 v173, v177, v177, v173
    v_dot2_f32_bf16 v174, v177, v189, v174
    v_dot2_f32_bf16 v172, v178, s63, v172
    v_dot2_f32_bf16 v173, v178, v178, v173
    v_dot2_f32_bf16 v174, v178, v190, v174
    s_waitcnt lgkmcnt(0)
    buffer_store_dwordx4 v[200:203], v165, s[44:47], s68 offen sc1
    v_dot2_f32_bf16 v172, v179, s63, v172
    v_dot2_f32_bf16 v173, v179, v179, v173
    v_dot2_f32_bf16 v174, v179, v191, v174
    buffer_store_dwordx4 v[204:207], v165, s[44:47], s69 offen sc1
    v_dot2_f32_bf16 v172, v180, s63, v172
    v_dot2_f32_bf16 v173, v180, v180, v173
    v_dot2_f32_bf16 v174, v180, v192, v174
    buffer_store_dwordx4 v[208:211], v165, s[44:47], s70 offen sc1
    v_dot2_f32_bf16 v172, v181, s63, v172
    v_dot2_f32_bf16 v173, v181, v181, v173
    v_dot2_f32_bf16 v174, v181, v193, v174
    buffer_store_dwordx4 v[212:215], v166, s[44:47], s71 offen sc1
    v_dot2_f32_bf16 v172, v182, s63, v172
    v_dot2_f32_bf16 v173, v182, v182, v173
    v_dot2_f32_bf16 v174, v182, v194, v174
    buffer_store_dwordx4 v[216:219], v166, s[44:47], s72 offen sc1
    v_dot2_f32_bf16 v172, v183, s63, v172
    v_dot2_f32_bf16 v173, v183, v183, v173
    v_dot2_f32_bf16 v174, v183, v195, v174
    buffer_store_dwordx4 v[220:223], v166, s[44:47], s75 offen sc1
    v_dot2_f32_bf16 v172, v184, s63, v172
    v_dot2_f32_bf16 v173, v184, v184, v173
    v_dot2_f32_bf16 v174, v184, v196, v174
    v_dot2_f32_bf16 v172, v185, s63, v172
    v_dot2_f32_bf16 v173, v185, v185, v173
    v_dot2_f32_bf16 v174, v185, v197, v174
    s_nop 0
    v_add_f32 v172, v172, v172 row_ror:8
    v_add_f32 v173, v173, v173 row_ror:8
    v_add_f32 v174, v174, v174 row_ror:8
    v_add_f32 v172, v172, v172 row_ror:4
    v_add_f32 v173, v173, v173 row_ror:4
    v_add_f32 v174, v174, v174 row_ror:4
    v_add_f32 v172, v172, v172 row_ror:2
    v_add_f32 v173, v173, v173 row_ror:2
    v_add_f32 v174, v174, v174 row_ror:2
    v_add_f32 v172, v172, v172 row_ror:1
    v_add_f32 v173, v173, v173 row_ror:1
    v_add_f32 v174, v174, v174 row_ror:1
    v_add_f32 v172, v172, v172 row_bcast:15 row_mask:0xa
    v_add_f32 v173, v173, v173 row_bcast:15 row_mask:0xa
    v_add_f32 v174, v174, v174 row_bcast:15 row_mask:0xa
    v_mul_f32 v172, 0xbacccccd, v172
    v_mul_f32 v173, 0x3acccccd, v173
    v_mul_f32 v174, 0xbfb8aa3b, v174
    v_fma_f32 v173, -v172, v172, v173
    v_exp_f32 v174, v174
    v_max_f32 v173, 0, v173
    v_add_f32 v173, 0x3727c5ac, v173
    v_cvt_pk_bf16_f32 v176, v172, v172
    v_rsq_f32 v175, v173
    v_sqrt_f32 v182, v173
    v_add_f32 v174, 1.0, v174
    v_and_b32 v177, 0xffff0000, v176
    v_rcp_f32 v183, v174
    v_sub_f32 v177, v172, v177
    v_cvt_pk_bf16_f32 v178, v182, v182
    v_cvt_pk_bf16_f32 v177, v177, v177
    v_and_b32 v178, 0xffff0000, v178
    v_sub_f32 v179, v182, v178
    v_cvt_pk_bf16_f32 v178, v178, v179
    v_mov_b32 v179, 0
    v_mul_f32 v180, 0xc0135761, v175
    v_mul_f32 v181, v175, v175
    v_mul_f32 v181, 0x3d372713, v181
    v_mul_f32 v181, v180, v181
    buffer_store_dwordx4 v[176:179], v167, s[44:47], s76 offen sc1
    buffer_store_dwordx4 v[180:183], v167, s[44:47], s76 offen offset:16 sc1
    s_barrier
    ds_read_b64_tr_b16 v[16:17], v10 offset:0
    ds_read_b64_tr_b16 v[18:19], v10 offset:1024
    ds_read_b128 v[24:27], v2 offset:0
    ds_read_b64_tr_b16 v[20:21], v11 offset:0
    ds_read_b64_tr_b16 v[22:23], v11 offset:1024
    ds_read_b128 v[28:31], v2 offset:4096
    s_waitcnt lgkmcnt(3)
    v_mfma_f32_32x32x16_bf16 v[80:95], v[16:19], v[24:27], 0
    ds_read_b64_tr_b16 v[32:33], v10 offset:4096
    ds_read_b64_tr_b16 v[34:35], v10 offset:5120
    ds_read_b128 v[40:43], v3 offset:0
    s_waitcnt lgkmcnt(4)
    v_mfma_f32_32x32x16_bf16 v[112:127], v[20:23], v[24:27], 0
    ds_read_b64_tr_b16 v[36:37], v11 offset:4096
    ds_read_b64_tr_b16 v[38:39], v11 offset:5120
    ds_read_b128 v[44:47], v3 offset:4096
    s_waitcnt lgkmcnt(6)
    v_mfma_f32_32x32x16_bf16 v[96:111], v[16:19], v[28:31], 0
    v_mfma_f32_32x32x16_bf16 v[128:143], v[20:23], v[28:31], 0
    v_mfma_f32_16x16x32_bf16 v[52:55], v[48:51], v[16:19], 0
    s_waitcnt lgkmcnt(3)
    v_mfma_f32_32x32x16_bf16 v[80:95], v[32:35], v[40:43], v[80:95]
    ds_read_b64_tr_b16 v[16:17], v10 offset:8192
    ds_read_b64_tr_b16 v[18:19], v10 offset:9216
    ds_read_b128 v[24:27], v4 offset:0
    s_waitcnt lgkmcnt(4)
    v_mfma_f32_32x32x16_bf16 v[112:127], v[36:39], v[40:43], v[112:127]
    ds_read_b64_tr_b16 v[20:21], v11 offset:8192
    ds_read_b64_tr_b16 v[22:23], v11 offset:9216
    ds_read_b128 v[28:31], v4 offset:4096
    s_waitcnt lgkmcnt(6)
    v_mfma_f32_32x32x16_bf16 v[96:111], v[32:35], v[44:47], v[96:111]
    v_mfma_f32_32x32x16_bf16 v[128:143], v[36:39], v[44:47], v[128:143]
    v_mfma_f32_16x16x32_bf16 v[52:55], v[48:51], v[32:35], v[52:55]
    s_waitcnt lgkmcnt(3)
    v_mfma_f32_32x32x16_bf16 v[80:95], v[16:19], v[24:27], v[80:95]
    ds_read_b64_tr_b16 v[32:33], v10 offset:12288
    ds_read_b64_tr_b16 v[34:35], v10 offset:13312
    ds_read_b128 v[40:43], v5 offset:0
    s_waitcnt lgkmcnt(4)
    v_mfma_f32_32x32x16_bf16 v[112:127], v[20:23], v[24:27], v[112:127]
    ds_read_b64_tr_b16 v[36:37], v11 offset:12288
    ds_read_b64_tr_b16 v[38:39], v11 offset:13312
    ds_read_b128 v[44:47], v5 offset:4096
    s_waitcnt lgkmcnt(6)
    v_mfma_f32_32x32x16_bf16 v[96:111], v[16:19], v[28:31], v[96:111]
    v_mfma_f32_32x32x16_bf16 v[128:143], v[20:23], v[28:31], v[128:143]
    v_mfma_f32_16x16x32_bf16 v[52:55], v[48:51], v[16:19], v[52:55]
    s_waitcnt lgkmcnt(3)
    v_mfma_f32_32x32x16_bf16 v[80:95], v[32:35], v[40:43], v[80:95]
    s_waitcnt lgkmcnt(0)
    s_barrier
    ds_read_b64_tr_b16 v[16:17], v10 offset:32768
    ds_read_b64_tr_b16 v[18:19], v10 offset:33792
    ds_read_b128 v[24:27], v2 offset:32768
    v_mfma_f32_32x32x16_bf16 v[112:127], v[36:39], v[40:43], v[112:127]
    ds_read_b64_tr_b16 v[20:21], v11 offset:32768
    ds_read_b64_tr_b16 v[22:23], v11 offset:33792
    ds_read_b128 v[28:31], v2 offset:36864
    v_mfma_f32_32x32x16_bf16 v[96:111], v[32:35], v[44:47], v[96:111]
    v_mfma_f32_32x32x16_bf16 v[128:143], v[36:39], v[44:47], v[128:143]
    v_mfma_f32_16x16x32_bf16 v[52:55], v[48:51], v[32:35], v[52:55]
    s_waitcnt lgkmcnt(3)
    v_mfma_f32_32x32x16_bf16 v[80:95], v[16:19], v[24:27], v[80:95]
    ds_read_b64_tr_b16 v[32:33], v10 offset:36864
    ds_read_b64_tr_b16 v[34:35], v10 offset:37888
    ds_read_b128 v[40:43], v3 offset:32768
    s_waitcnt lgkmcnt(4)
    v_mfma_f32_32x32x16_bf16 v[112:127], v[20:23], v[24:27], v[112:127]
    ds_read_b64_tr_b16 v[36:37], v11 offset:36864
    ds_read_b64_tr_b16 v[38:39], v11 offset:37888
    ds_read_b128 v[44:47], v3 offset:36864
    s_waitcnt lgkmcnt(6)
    v_mfma_f32_32x32x16_bf16 v[96:111], v[16:19], v[28:31], v[96:111]
    v_mfma_f32_32x32x16_bf16 v[128:143], v[20:23], v[28:31], v[128:143]
    v_mfma_f32_16x16x32_bf16 v[52:55], v[48:51], v[16:19], v[52:55]
    s_waitcnt lgkmcnt(3)
    v_mfma_f32_32x32x16_bf16 v[80:95], v[32:35], v[40:43], v[80:95]
    ds_read_b64_tr_b16 v[16:17], v10 offset:40960
    ds_read_b64_tr_b16 v[18:19], v10 offset:41984
    ds_read_b128 v[24:27], v4 offset:32768
    s_waitcnt lgkmcnt(4)
    v_mfma_f32_32x32x16_bf16 v[112:127], v[36:39], v[40:43], v[112:127]
    ds_read_b64_tr_b16 v[20:21], v11 offset:40960
    ds_read_b64_tr_b16 v[22:23], v11 offset:41984
    ds_read_b128 v[28:31], v4 offset:36864
    s_waitcnt lgkmcnt(6)
    v_mfma_f32_32x32x16_bf16 v[96:111], v[32:35], v[44:47], v[96:111]
    v_mfma_f32_32x32x16_bf16 v[128:143], v[36:39], v[44:47], v[128:143]
    v_mfma_f32_16x16x32_bf16 v[52:55], v[48:51], v[32:35], v[52:55]
    s_waitcnt lgkmcnt(3)
    v_mfma_f32_32x32x16_bf16 v[80:95], v[16:19], v[24:27], v[80:95]
    ds_read_b64_tr_b16 v[32:33], v10 offset:45056
    ds_read_b64_tr_b16 v[34:35], v10 offset:46080
    ds_read_b128 v[40:43], v5 offset:32768
    s_waitcnt lgkmcnt(4)
    v_mfma_f32_32x32x16_bf16 v[112:127], v[20:23], v[24:27], v[112:127]
    ds_read_b64_tr_b16 v[36:37], v11 offset:45056
    ds_read_b64_tr_b16 v[38:39], v11 offset:46080
    ds_read_b128 v[44:47], v5 offset:36864
    s_waitcnt lgkmcnt(6)
    v_mfma_f32_32x32x16_bf16 v[96:111], v[16:19], v[28:31], v[96:111]
    v_mfma_f32_32x32x16_bf16 v[128:143], v[20:23], v[28:31], v[128:143]
    v_mfma_f32_16x16x32_bf16 v[52:55], v[48:51], v[16:19], v[52:55]
    s_waitcnt lgkmcnt(3)
    v_mfma_f32_32x32x16_bf16 v[80:95], v[32:35], v[40:43], v[80:95]
    s_waitcnt lgkmcnt(0)
    s_barrier
    ds_read_b64_tr_b16 v[16:17], v12 offset:0
    ds_read_b64_tr_b16 v[18:19], v12 offset:1024
    ds_read_b128 v[24:27], v6 offset:0
    v_mfma_f32_32x32x16_bf16 v[112:127], v[36:39], v[40:43], v[112:127]
    ds_read_b64_tr_b16 v[20:21], v13 offset:0
    ds_read_b64_tr_b16 v[22:23], v13 offset:1024
    ds_read_b128 v[28:31], v6 offset:4096
    v_mfma_f32_32x32x16_bf16 v[96:111], v[32:35], v[44:47], v[96:111]
    buffer_load_dword v250, v248, s[92:95], 0 offen sc1
    v_mfma_f32_32x32x16_bf16 v[128:143], v[36:39], v[44:47], v[128:143]
    v_mfma_f32_16x16x32_bf16 v[52:55], v[48:51], v[32:35], v[52:55]
    s_waitcnt lgkmcnt(3)
    v_mfma_f32_32x32x16_bf16 v[80:95], v[16:19], v[24:27], v[80:95]
    ds_read_b64_tr_b16 v[32:33], v12 offset:4096
    ds_read_b64_tr_b16 v[34:35], v12 offset:5120
    ds_read_b128 v[40:43], v7 offset:0
    s_waitcnt lgkmcnt(4)
    v_mfma_f32_32x32x16_bf16 v[112:127], v[20:23], v[24:27], v[112:127]
    ds_read_b64_tr_b16 v[36:37], v13 offset:4096
    ds_read_b64_tr_b16 v[38:39], v13 offset:5120
    ds_read_b128 v[44:47], v7 offset:4096
    s_waitcnt lgkmcnt(6)
    v_mfma_f32_32x32x16_bf16 v[96:111], v[16:19], v[28:31], v[96:111]
    v_mfma_f32_32x32x16_bf16 v[128:143], v[20:23], v[28:31], v[128:143]
    v_mfma_f32_16x16x32_bf16 v[52:55], v[48:51], v[16:19], v[52:55]
    s_waitcnt lgkmcnt(3)
    v_mfma_f32_32x32x16_bf16 v[80:95], v[32:35], v[40:43], v[80:95]
    ds_read_b64_tr_b16 v[16:17], v12 offset:8192
    ds_read_b64_tr_b16 v[18:19], v12 offset:9216
    ds_read_b128 v[24:27], v8 offset:0
    s_waitcnt lgkmcnt(4)
    v_mfma_f32_32x32x16_bf16 v[112:127], v[36:39], v[40:43], v[112:127]
    ds_read_b64_tr_b16 v[20:21], v13 offset:8192
    ds_read_b64_tr_b16 v[22:23], v13 offset:9216
    ds_read_b128 v[28:31], v8 offset:4096
    s_waitcnt lgkmcnt(6)
    v_mfma_f32_32x32x16_bf16 v[96:111], v[32:35], v[44:47], v[96:111]
    v_mfma_f32_32x32x16_bf16 v[128:143], v[36:39], v[44:47], v[128:143]
    v_mfma_f32_16x16x32_bf16 v[52:55], v[48:51], v[32:35], v[52:55]
    s_waitcnt lgkmcnt(3)
    v_mfma_f32_32x32x16_bf16 v[80:95], v[16:19], v[24:27], v[80:95]
    ds_read_b64_tr_b16 v[32:33], v12 offset:12288
    ds_read_b64_tr_b16 v[34:35], v12 offset:13312
    ds_read_b128 v[40:43], v9 offset:0
    s_waitcnt lgkmcnt(4)
    v_mfma_f32_32x32x16_bf16 v[112:127], v[20:23], v[24:27], v[112:127]
    ds_read_b64_tr_b16 v[36:37], v13 offset:12288
    ds_read_b64_tr_b16 v[38:39], v13 offset:13312
    ds_read_b128 v[44:47], v9 offset:4096
    s_waitcnt lgkmcnt(6)
    v_mfma_f32_32x32x16_bf16 v[96:111], v[16:19], v[28:31], v[96:111]
    v_mfma_f32_32x32x16_bf16 v[128:143], v[20:23], v[28:31], v[128:143]
    v_mfma_f32_16x16x32_bf16 v[52:55], v[48:51], v[16:19], v[52:55]
    s_waitcnt lgkmcnt(3)
    v_mfma_f32_32x32x16_bf16 v[80:95], v[32:35], v[40:43], v[80:95]
    s_waitcnt lgkmcnt(0)
    s_waitcnt vmcnt(0)
    s_waitcnt vmcnt(0)
    s_mov_b32 s89, 0x20000
gated_mix__ssm_conv_s4d__mixer_channel_mlp__prompt_kernel_sp27:
    v_cmp_ne_u32 s[90:91], v249, v250
    s_sub_u32 s89, s89, 1
    s_cselect_b64 s[90:91], 0, s[90:91]
    s_cmp_eq_u64 s[90:91], 0
    s_cbranch_scc1 gated_mix__ssm_conv_s4d__mixer_channel_mlp__prompt_kernel_sd28
    s_nop 0
    buffer_load_dword v250, v248, s[92:95], 0 offen sc1
    s_waitcnt vmcnt(0)
    s_branch gated_mix__ssm_conv_s4d__mixer_channel_mlp__prompt_kernel_sp27
gated_mix__ssm_conv_s4d__mixer_channel_mlp__prompt_kernel_sd28:
    s_barrier
    ds_read_b64_tr_b16 v[16:17], v12 offset:32768
    ds_read_b64_tr_b16 v[18:19], v12 offset:33792
    ds_read_b128 v[24:27], v6 offset:32768
    v_mfma_f32_32x32x16_bf16 v[112:127], v[36:39], v[40:43], v[112:127]
    ds_read_b64_tr_b16 v[20:21], v13 offset:32768
    ds_read_b64_tr_b16 v[22:23], v13 offset:33792
    ds_read_b128 v[28:31], v6 offset:36864
    buffer_atomic_add v252, v251, s[44:47], s98 offen sc1
    v_mfma_f32_32x32x16_bf16 v[96:111], v[32:35], v[44:47], v[96:111]
    s_cmp_eq_u32 s3, 0
    s_cselect_b32 s89, 8, 0
    v_mfma_f32_32x32x16_bf16 v[128:143], v[36:39], v[44:47], v[128:143]
    v_mfma_f32_16x16x32_bf16 v[52:55], v[48:51], v[32:35], v[52:55]
    s_waitcnt lgkmcnt(3)
    v_mfma_f32_32x32x16_bf16 v[80:95], v[16:19], v[24:27], v[80:95]
    ds_read_b64_tr_b16 v[32:33], v12 offset:36864
    ds_read_b64_tr_b16 v[34:35], v12 offset:37888
    ds_read_b128 v[40:43], v7 offset:32768
    s_waitcnt lgkmcnt(4)
    v_mfma_f32_32x32x16_bf16 v[112:127], v[20:23], v[24:27], v[112:127]
    ds_read_b64_tr_b16 v[36:37], v13 offset:36864
    ds_read_b64_tr_b16 v[38:39], v13 offset:37888
    ds_read_b128 v[44:47], v7 offset:36864
    s_waitcnt lgkmcnt(6)
    v_mfma_f32_32x32x16_bf16 v[96:111], v[16:19], v[28:31], v[96:111]
    v_cmp_gt_u32 s[90:91], s89, v0
    v_mfma_f32_32x32x16_bf16 v[128:143], v[20:23], v[28:31], v[128:143]
    v_lshlrev_b32 v248, 11, v0
    v_mfma_f32_16x16x32_bf16 v[52:55], v[48:51], v[16:19], v[52:55]
    s_waitcnt lgkmcnt(3)
    v_mfma_f32_32x32x16_bf16 v[80:95], v[32:35], v[40:43], v[80:95]
    ds_read_b64_tr_b16 v[16:17], v12 offset:40960
    ds_read_b64_tr_b16 v[18:19], v12 offset:41984
    ds_read_b128 v[24:27], v8 offset:32768
    s_waitcnt lgkmcnt(4)
    v_mfma_f32_32x32x16_bf16 v[112:127], v[36:39], v[40:43], v[112:127]
    ds_read_b64_tr_b16 v[20:21], v13 offset:40960
    ds_read_b64_tr_b16 v[22:23], v13 offset:41984
    ds_read_b128 v[28:31], v8 offset:36864
    s_waitcnt lgkmcnt(6)
    v_mfma_f32_32x32x16_bf16 v[96:111], v[32:35], v[44:47], v[96:111]
    v_mov_b32 v249, 1073741824
    v_mfma_f32_32x32x16_bf16 v[128:143], v[36:39], v[44:47], v[128:143]
    v_cndmask_b32 v248, v249, v248, s[90:91]
    v_mfma_f32_16x16x32_bf16 v[52:55], v[48:51], v[32:35], v[52:55]
    s_waitcnt lgkmcnt(3)
    v_mfma_f32_32x32x16_bf16 v[80:95], v[16:19], v[24:27], v[80:95]
    ds_read_b64_tr_b16 v[32:33], v12 offset:45056
    ds_read_b64_tr_b16 v[34:35], v12 offset:46080
    ds_read_b128 v[40:43], v9 offset:32768
    s_waitcnt lgkmcnt(4)
    v_mfma_f32_32x32x16_bf16 v[112:127], v[20:23], v[24:27], v[112:127]
    ds_read_b64_tr_b16 v[36:37], v13 offset:45056
    ds_read_b64_tr_b16 v[38:39], v13 offset:46080
    ds_read_b128 v[44:47], v9 offset:36864
    s_waitcnt lgkmcnt(6)
    v_mfma_f32_32x32x16_bf16 v[96:111], v[16:19], v[28:31], v[96:111]
    v_cndmask_b32 v249, 0, 32, s[90:91]
    s_and_b32 s89, s2, 7
    s_lshl_b32 s89, s89, 8
    v_mfma_f32_32x32x16_bf16 v[128:143], v[20:23], v[28:31], v[128:143]
    v_add_u32 v248, s89, v248
    v_mfma_f32_16x16x32_bf16 v[52:55], v[48:51], v[16:19], v[52:55]
    s_waitcnt lgkmcnt(3)
    v_mfma_f32_32x32x16_bf16 v[80:95], v[32:35], v[40:43], v[80:95]
    s_waitcnt lgkmcnt(0)
    s_barrier
    ds_read_b64_tr_b16 v[16:17], v10 offset:0
    ds_read_b64_tr_b16 v[18:19], v10 offset:1024
    ds_read_b128 v[24:27], v2 offset:0
    v_mfma_f32_32x32x16_bf16 v[112:127], v[36:39], v[40:43], v[112:127]
    ds_read_b64_tr_b16 v[20:21], v11 offset:0
    ds_read_b64_tr_b16 v[22:23], v11 offset:1024
    ds_read_b128 v[28:31], v2 offset:4096
    v_mfma_f32_32x32x16_bf16 v[96:111], v[32:35], v[44:47], v[96:111]
    v_mfma_f32_32x32x16_bf16 v[128:143], v[36:39], v[44:47], v[128:143]
    v_mfma_f32_16x16x32_bf16 v[52:55], v[48:51], v[32:35], v[52:55]
    s_waitcnt lgkmcnt(3)
    v_mfma_f32_32x32x16_bf16 v[80:95], v[16:19], v[24:27], v[80:95]
    ds_read_b64_tr_b16 v[32:33], v10 offset:4096
    ds_read_b64_tr_b16 v[34:35], v10 offset:5120
    ds_read_b128 v[40:43], v3 offset:0
    s_waitcnt lgkmcnt(4)
    v_mfma_f32_32x32x16_bf16 v[112:127], v[20:23], v[24:27], v[112:127]
    ds_read_b64_tr_b16 v[36:37], v11 offset:4096
    ds_read_b64_tr_b16 v[38:39], v11 offset:5120
    ds_read_b128 v[44:47], v3 offset:4096
    s_waitcnt lgkmcnt(6)
    v_mfma_f32_32x32x16_bf16 v[96:111], v[16:19], v[28:31], v[96:111]
    v_mfma_f32_32x32x16_bf16 v[128:143], v[20:23], v[28:31], v[128:143]
    v_mfma_f32_16x16x32_bf16 v[52:55], v[48:51], v[16:19], v[52:55]
    s_waitcnt lgkmcnt(3)
    v_mfma_f32_32x32x16_bf16 v[80:95], v[32:35], v[40:43], v[80:95]
    ds_read_b64_tr_b16 v[16:17], v10 offset:8192
    ds_read_b64_tr_b16 v[18:19], v10 offset:9216
    ds_read_b128 v[24:27], v4 offset:0
    s_waitcnt lgkmcnt(4)
    v_mfma_f32_32x32x16_bf16 v[112:127], v[36:39], v[40:43], v[112:127]
    ds_read_b64_tr_b16 v[20:21], v11 offset:8192
    ds_read_b64_tr_b16 v[22:23], v11 offset:9216
    ds_read_b128 v[28:31], v4 offset:4096
    s_waitcnt lgkmcnt(6)
    v_mfma_f32_32x32x16_bf16 v[96:111], v[32:35], v[44:47], v[96:111]
    v_mfma_f32_32x32x16_bf16 v[128:143], v[36:39], v[44:47], v[128:143]
    v_mfma_f32_16x16x32_bf16 v[52:55], v[48:51], v[32:35], v[52:55]
    s_waitcnt lgkmcnt(3)
    v_mfma_f32_32x32x16_bf16 v[80:95], v[16:19], v[24:27], v[80:95]
    ds_read_b64_tr_b16 v[32:33], v10 offset:12288
    ds_read_b64_tr_b16 v[34:35], v10 offset:13312
    ds_read_b128 v[40:43], v5 offset:0
    s_waitcnt lgkmcnt(4)
    v_mfma_f32_32x32x16_bf16 v[112:127], v[20:23], v[24:27], v[112:127]
    ds_read_b64_tr_b16 v[36:37], v11 offset:12288
    ds_read_b64_tr_b16 v[38:39], v11 offset:13312
    ds_read_b128 v[44:47], v5 offset:4096
    s_waitcnt lgkmcnt(6)
    v_mfma_f32_32x32x16_bf16 v[96:111], v[16:19], v[28:31], v[96:111]
    v_mfma_f32_32x32x16_bf16 v[128:143], v[20:23], v[28:31], v[128:143]
    v_mfma_f32_16x16x32_bf16 v[52:55], v[48:51], v[16:19], v[52:55]
    s_waitcnt lgkmcnt(3)
    v_mfma_f32_32x32x16_bf16 v[80:95], v[32:35], v[40:43], v[80:95]
    s_waitcnt lgkmcnt(0)
    s_barrier
    ds_read_b64_tr_b16 v[16:17], v10 offset:32768
    ds_read_b64_tr_b16 v[18:19], v10 offset:33792
    ds_read_b128 v[24:27], v2 offset:32768
    v_mfma_f32_32x32x16_bf16 v[112:127], v[36:39], v[40:43], v[112:127]
    ds_read_b64_tr_b16 v[20:21], v11 offset:32768
    ds_read_b64_tr_b16 v[22:23], v11 offset:33792
    ds_read_b128 v[28:31], v2 offset:36864
    v_mfma_f32_32x32x16_bf16 v[96:111], v[32:35], v[44:47], v[96:111]
    buffer_load_dword v250, v248, s[44:47], 0 offen sc1
    v_mfma_f32_32x32x16_bf16 v[128:143], v[36:39], v[44:47], v[128:143]
    v_mfma_f32_16x16x32_bf16 v[52:55], v[48:51], v[32:35], v[52:55]
    s_waitcnt lgkmcnt(3)
    v_mfma_f32_32x32x16_bf16 v[80:95], v[16:19], v[24:27], v[80:95]
    ds_read_b64_tr_b16 v[32:33], v10 offset:36864
    ds_read_b64_tr_b16 v[34:35], v10 offset:37888
    ds_read_b128 v[40:43], v3 offset:32768
    s_waitcnt lgkmcnt(4)
    v_mfma_f32_32x32x16_bf16 v[112:127], v[20:23], v[24:27], v[112:127]
    ds_read_b64_tr_b16 v[36:37], v11 offset:36864
    ds_read_b64_tr_b16 v[38:39], v11 offset:37888
    ds_read_b128 v[44:47], v3 offset:36864
    s_waitcnt lgkmcnt(6)
    v_mfma_f32_32x32x16_bf16 v[96:111], v[16:19], v[28:31], v[96:111]
    v_mfma_f32_32x32x16_bf16 v[128:143], v[20:23], v[28:31], v[128:143]
    v_mfma_f32_16x16x32_bf16 v[52:55], v[48:51], v[16:19], v[52:55]
    s_waitcnt lgkmcnt(3)
    v_mfma_f32_32x32x16_bf16 v[80:95], v[32:35], v[40:43], v[80:95]
    ds_read_b64_tr_b16 v[16:17], v10 offset:40960
    ds_read_b64_tr_b16 v[18:19], v10 offset:41984
    ds_read_b128 v[24:27], v4 offset:32768
    s_waitcnt lgkmcnt(4)
    v_mfma_f32_32x32x16_bf16 v[112:127], v[36:39], v[40:43], v[112:127]
    ds_read_b64_tr_b16 v[20:21], v11 offset:40960
    ds_read_b64_tr_b16 v[22:23], v11 offset:41984
    ds_read_b128 v[28:31], v4 offset:36864
    s_waitcnt lgkmcnt(6)
    v_mfma_f32_32x32x16_bf16 v[96:111], v[32:35], v[44:47], v[96:111]
    v_mfma_f32_32x32x16_bf16 v[128:143], v[36:39], v[44:47], v[128:143]
    v_mfma_f32_16x16x32_bf16 v[52:55], v[48:51], v[32:35], v[52:55]
    s_waitcnt lgkmcnt(3)
    v_mfma_f32_32x32x16_bf16 v[80:95], v[16:19], v[24:27], v[80:95]
    ds_read_b64_tr_b16 v[32:33], v10 offset:45056
    ds_read_b64_tr_b16 v[34:35], v10 offset:46080
    ds_read_b128 v[40:43], v5 offset:32768
    s_waitcnt lgkmcnt(4)
    v_mfma_f32_32x32x16_bf16 v[112:127], v[20:23], v[24:27], v[112:127]
    ds_read_b64_tr_b16 v[36:37], v11 offset:45056
    ds_read_b64_tr_b16 v[38:39], v11 offset:46080
    ds_read_b128 v[44:47], v5 offset:36864
    s_waitcnt lgkmcnt(6)
    v_mfma_f32_32x32x16_bf16 v[96:111], v[16:19], v[28:31], v[96:111]
    v_mfma_f32_32x32x16_bf16 v[128:143], v[20:23], v[28:31], v[128:143]
    v_mfma_f32_16x16x32_bf16 v[52:55], v[48:51], v[16:19], v[52:55]
    s_waitcnt lgkmcnt(3)
    v_mfma_f32_32x32x16_bf16 v[80:95], v[32:35], v[40:43], v[80:95]
    s_waitcnt lgkmcnt(0)
    s_barrier
    ds_read_b64_tr_b16 v[16:17], v12 offset:0
    ds_read_b64_tr_b16 v[18:19], v12 offset:1024
    ds_read_b128 v[24:27], v6 offset:0
    v_mfma_f32_32x32x16_bf16 v[112:127], v[36:39], v[40:43], v[112:127]
    ds_read_b64_tr_b16 v[20:21], v13 offset:0
    ds_read_b64_tr_b16 v[22:23], v13 offset:1024
    ds_read_b128 v[28:31], v6 offset:4096
    v_mfma_f32_32x32x16_bf16 v[96:111], v[32:35], v[44:47], v[96:111]
    v_mfma_f32_32x32x16_bf16 v[128:143], v[36:39], v[44:47], v[128:143]
    v_mfma_f32_16x16x32_bf16 v[52:55], v[48:51], v[32:35], v[52:55]
    s_waitcnt lgkmcnt(3)
    v_mfma_f32_32x32x16_bf16 v[80:95], v[16:19], v[24:27], v[80:95]
    ds_read_b64_tr_b16 v[32:33], v12 offset:4096
    ds_read_b64_tr_b16 v[34:35], v12 offset:5120
    ds_read_b128 v[40:43], v7 offset:0
    s_waitcnt lgkmcnt(4)
    v_mfma_f32_32x32x16_bf16 v[112:127], v[20:23], v[24:27], v[112:127]
    ds_read_b64_tr_b16 v[36:37], v13 offset:4096
    ds_read_b64_tr_b16 v[38:39], v13 offset:5120
    ds_read_b128 v[44:47], v7 offset:4096
    s_waitcnt lgkmcnt(6)
    v_mfma_f32_32x32x16_bf16 v[96:111], v[16:19], v[28:31], v[96:111]
    v_mfma_f32_32x32x16_bf16 v[128:143], v[20:23], v[28:31], v[128:143]
    v_mfma_f32_16x16x32_bf16 v[52:55], v[48:51], v[16:19], v[52:55]
    s_waitcnt lgkmcnt(3)
    v_mfma_f32_32x32x16_bf16 v[80:95], v[32:35], v[40:43], v[80:95]
    ds_read_b64_tr_b16 v[16:17], v12 offset:8192
    ds_read_b64_tr_b16 v[18:19], v12 offset:9216
    ds_read_b128 v[24:27], v8 offset:0
    s_waitcnt lgkmcnt(4)
    v_mfma_f32_32x32x16_bf16 v[112:127], v[36:39], v[40:43], v[112:127]
    ds_read_b64_tr_b16 v[20:21], v13 offset:8192
    ds_read_b64_tr_b16 v[22:23], v13 offset:9216
    ds_read_b128 v[28:31], v8 offset:4096
    s_waitcnt lgkmcnt(6)
    v_mfma_f32_32x32x16_bf16 v[96:111], v[32:35], v[44:47], v[96:111]
    v_mfma_f32_32x32x16_bf16 v[128:143], v[36:39], v[44:47], v[128:143]
    v_mfma_f32_16x16x32_bf16 v[52:55], v[48:51], v[32:35], v[52:55]
    s_waitcnt lgkmcnt(3)
    v_mfma_f32_32x32x16_bf16 v[80:95], v[16:19], v[24:27], v[80:95]
    ds_read_b64_tr_b16 v[32:33], v12 offset:12288
    ds_read_b64_tr_b16 v[34:35], v12 offset:13312
    ds_read_b128 v[40:43], v9 offset:0
    s_waitcnt lgkmcnt(4)
    v_mfma_f32_32x32x16_bf16 v[112:127], v[20:23], v[24:27], v[112:127]
    ds_read_b64_tr_b16 v[36:37], v13 offset:12288
    ds_read_b64_tr_b16 v[38:39], v13 offset:13312
    ds_read_b128 v[44:47], v9 offset:4096
    s_waitcnt lgkmcnt(6)
    v_mfma_f32_32x32x16_bf16 v[96:111], v[16:19], v[28:31], v[96:111]
    v_mfma_f32_32x32x16_bf16 v[128:143], v[20:23], v[28:31], v[128:143]
    v_mfma_f32_16x16x32_bf16 v[52:55], v[48:51], v[16:19], v[52:55]
    s_waitcnt lgkmcnt(3)
    v_mfma_f32_32x32x16_bf16 v[80:95], v[32:35], v[40:43], v[80:95]
    s_waitcnt lgkmcnt(0)
    s_waitcnt vmcnt(0)
    s_mov_b32 s89, 0x20000
gated_mix__ssm_conv_s4d__mixer_channel_mlp__prompt_kernel_sp29:
    v_cmp_ne_u32 s[90:91], v249, v250
    s_sub_u32 s89, s89, 1
    s_cselect_b64 s[90:91], 0, s[90:91]
    s_cmp_eq_u64 s[90:91], 0
    s_cbranch_scc1 gated_mix__ssm_conv_s4d__mixer_channel_mlp__prompt_kernel_sd30
    s_nop 0
    buffer_load_dword v250, v248, s[44:47], 0 offen sc1
    s_waitcnt vmcnt(0)
    s_branch gated_mix__ssm_conv_s4d__mixer_channel_mlp__prompt_kernel_sp29
gated_mix__ssm_conv_s4d__mixer_channel_mlp__prompt_kernel_sd30:
    s_barrier
    ds_read_b64_tr_b16 v[16:17], v12 offset:32768
    ds_read_b64_tr_b16 v[18:19], v12 offset:33792
    ds_read_b128 v[24:27], v6 offset:32768
    v_mfma_f32_32x32x16_bf16 v[112:127], v[36:39], v[40:43], v[112:127]
    ds_read_b64_tr_b16 v[20:21], v13 offset:32768
    ds_read_b64_tr_b16 v[22:23], v13 offset:33792
    ds_read_b128 v[28:31], v6 offset:36864
    v_mfma_f32_32x32x16_bf16 v[96:111], v[32:35], v[44:47], v[96:111]
    buffer_load_dwordx4 v[64:67], v58, s[44:47], s82 offen offset:0 sc1
    v_mfma_f32_32x32x16_bf16 v[128:143], v[36:39], v[44:47], v[128:143]
    v_mfma_f32_16x16x32_bf16 v[52:55], v[48:51], v[32:35], v[52:55]
    s_waitcnt lgkmcnt(3)
    v_mfma_f32_32x32x16_bf16 v[80:95], v[16:19], v[24:27], v[80:95]
    ds_read_b64_tr_b16 v[32:33], v12 offset:36864
    ds_read_b64_tr_b16 v[34:35], v12 offset:37888
    ds_read_b128 v[40:43], v7 offset:32768
    s_waitcnt lgkmcnt(4)
    v_mfma_f32_32x32x16_bf16 v[112:127], v[20:23], v[24:27], v[112:127]
    ds_read_b64_tr_b16 v[36:37], v13 offset:36864
    ds_read_b64_tr_b16 v[38:39], v13 offset:37888
    ds_read_b128 v[44:47], v7 offset:36864
    s_waitcnt lgkmcnt(6)
    v_mfma_f32_32x32x16_bf16 v[96:111], v[16:19], v[28:31], v[96:111]
    buffer_load_dwordx4 v[68:71], v58, s[44:47], s82 offen offset:16 sc1
    v_mfma_f32_32x32x16_bf16 v[128:143], v[20:23], v[28:31], v[128:143]
    buffer_load_dwordx4 v[72:75], v58, s[44:47], s82 offen offset:1024 sc1
    v_mfma_f32_16x16x32_bf16 v[52:55], v[48:51], v[16:19], v[52:55]
    s_waitcnt lgkmcnt(3)
    v_mfma_f32_32x32x16_bf16 v[80:95], v[32:35], v[40:43], v[80:95]
    ds_read_b64_tr_b16 v[16:17], v12 offset:40960
    ds_read_b64_tr_b16 v[18:19], v12 offset:41984
    ds_read_b128 v[24:27], v8 offset:32768
    s_waitcnt lgkmcnt(4)
    v_mfma_f32_32x32x16_bf16 v[112:127], v[36:39], v[40:43], v[112:127]
    ds_read_b64_tr_b16 v[20:21], v13 offset:40960
    ds_read_b64_tr_b16 v[22:23], v13 offset:41984
    ds_read_b128 v[28:31], v8 offset:36864
    s_waitcnt lgkmcnt(6)
    v_mfma_f32_32x32x16_bf16 v[96:111], v[32:35], v[44:47], v[96:111]
    buffer_load_dwordx4 v[76:79], v58, s[44:47], s82 offen offset:1040 sc1
    s_cmp_eq_u32 s3, 0
    s_cselect_b32 s89, 1, 0
    v_mfma_f32_32x32x16_bf16 v[128:143], v[36:39], v[44:47], v[128:143]
    v_cmp_gt_u32 s[90:91], s89, v0
    v_mfma_f32_16x16x32_bf16 v[52:55], v[48:51], v[32:35], v[52:55]
    s_waitcnt lgkmcnt(3)
    v_mfma_f32_32x32x16_bf16 v[80:95], v[16:19], v[24:27], v[80:95]
    ds_read_b64_tr_b16 v[32:33], v12 offset:45056
    ds_read_b64_tr_b16 v[34:35], v12 offset:46080
    ds_read_b128 v[40:43], v9 offset:32768
    s_waitcnt lgkmcnt(4)
    v_mfma_f32_32x32x16_bf16 v[112:127], v[20:23], v[24:27], v[112:127]
    ds_read_b64_tr_b16 v[36:37], v13 offset:45056
    ds_read_b64_tr_b16 v[38:39], v13 offset:46080
    ds_read_b128 v[44:47], v9 offset:36864
    s_waitcnt lgkmcnt(6)
    v_mfma_f32_32x32x16_bf16 v[96:111], v[16:19], v[28:31], v[96:111]
    v_lshlrev_b32 v248, 8, v0
    v_mfma_f32_32x32x16_bf16 v[128:143], v[20:23], v[28:31], v[128:143]
    v_mov_b32 v249, 1073741824
    v_mfma_f32_16x16x32_bf16 v[52:55], v[48:51], v[16:19], v[52:55]
    s_waitcnt lgkmcnt(3)
    v_mfma_f32_32x32x16_bf16 v[80:95], v[32:35], v[40:43], v[80:95]
    s_waitcnt lgkmcnt(0)
    s_barrier
    ds_read_b64_tr_b16 v[16:17], v10 offset:0
    ds_read_b64_tr_b16 v[18:19], v10 offset:1024
    ds_read_b128 v[24:27], v2 offset:0
    v_mfma_f32_32x32x16_bf16 v[112:127], v[36:39], v[40:43], v[112:127]
    ds_read_b64_tr_b16 v[20:21], v11 offset:0
    ds_read_b64_tr_b16 v[22:23], v11 offset:1024
    ds_read_b128 v[28:31], v2 offset:4096
    v_mfma_f32_32x32x16_bf16 v[96:111], v[32:35], v[44:47], v[96:111]
    v_cndmask_b32 v248, v249, v248, s[90:91]
    v_mfma_f32_32x32x16_bf16 v[128:143], v[36:39], v[44:47], v[128:143]
    v_mfma_f32_16x16x32_bf16 v[52:55], v[48:51], v[32:35], v[52:55]
    s_waitcnt lgkmcnt(3)
    v_mfma_f32_32x32x16_bf16 v[80:95], v[16:19], v[24:27], v[80:95]
    ds_read_b64_tr_b16 v[32:33], v10 offset:4096
    ds_read_b64_tr_b16 v[34:35], v10 offset:5120
    ds_read_b128 v[40:43], v3 offset:0
    s_waitcnt lgkmcnt(4)
    v_mfma_f32_32x32x16_bf16 v[112:127], v[20:23], v[24:27], v[112:127]
    ds_read_b64_tr_b16 v[36:37], v11 offset:4096
    ds_read_b64_tr_b16 v[38:39], v11 offset:5120
    ds_read_b128 v[44:47], v3 offset:4096
    s_waitcnt lgkmcnt(6)
    v_mfma_f32_32x32x16_bf16 v[96:111], v[16:19], v[28:31], v[96:111]
    v_cndmask_b32 v249, 0, 28, s[90:91]
    s_mul_i32 s98, s81, 8
    s_add_u32 s98, s98, 512
    s_lshl_b32 s98, s98, 8
    v_mfma_f32_32x32x16_bf16 v[128:143], v[20:23], v[28:31], v[128:143]
    v_cmp_gt_u32 s[90:91], 8, v0
    v_mfma_f32_16x16x32_bf16 v[52:55], v[48:51], v[16:19], v[52:55]
    s_waitcnt lgkmcnt(3)
    v_mfma_f32_32x32x16_bf16 v[80:95], v[32:35], v[40:43], v[80:95]
    ds_read_b64_tr_b16 v[16:17], v10 offset:8192
    ds_read_b64_tr_b16 v[18:19], v10 offset:9216
    ds_read_b128 v[24:27], v4 offset:0
    s_waitcnt lgkmcnt(4)
    v_mfma_f32_32x32x16_bf16 v[112:127], v[36:39], v[40:43], v[112:127]
    ds_read_b64_tr_b16 v[20:21], v11 offset:8192
    ds_read_b64_tr_b16 v[22:23], v11 offset:9216
    ds_read_b128 v[28:31], v4 offset:4096
    s_waitcnt lgkmcnt(6)
    v_mfma_f32_32x32x16_bf16 v[96:111], v[32:35], v[44:47], v[96:111]
    v_mov_b32 v252, 1073741824
    v_mfma_f32_32x32x16_bf16 v[128:143], v[36:39], v[44:47], v[128:143]
    v_lshlrev_b32 v251, 8, v0
    v_mfma_f32_16x16x32_bf16 v[52:55], v[48:51], v[32:35], v[52:55]
    s_waitcnt lgkmcnt(3)
    v_mfma_f32_32x32x16_bf16 v[80:95], v[16:19], v[24:27], v[80:95]
    ds_read_b64_tr_b16 v[32:33], v10 offset:12288
    ds_read_b64_tr_b16 v[34:35], v10 offset:13312
    ds_read_b128 v[40:43], v5 offset:0
    s_waitcnt lgkmcnt(4)
    v_mfma_f32_32x32x16_bf16 v[112:127], v[20:23], v[24:27], v[112:127]
    ds_read_b64_tr_b16 v[36:37], v11 offset:12288
    ds_read_b64_tr_b16 v[38:39], v11 offset:13312
    ds_read_b128 v[44:47], v5 offset:4096
    s_waitcnt lgkmcnt(6)
    v_mfma_f32_32x32x16_bf16 v[96:111], v[16:19], v[28:31], v[96:111]
    v_cndmask_b32 v251, v252, v251, s[90:91]
    v_mfma_f32_32x32x16_bf16 v[128:143], v[20:23], v[28:31], v[128:143]
    v_mov_b32 v252, 1
    v_mfma_f32_16x16x32_bf16 v[52:55], v[48:51], v[16:19], v[52:55]
    s_waitcnt lgkmcnt(3)
    v_mfma_f32_32x32x16_bf16 v[80:95], v[32:35], v[40:43], v[80:95]
    s_waitcnt lgkmcnt(0)
    s_barrier
    ds_read_b64_tr_b16 v[16:17], v10 offset:32768
    ds_read_b64_tr_b16 v[18:19], v10 offset:33792
    ds_read_b128 v[24:27], v2 offset:32768
    v_mfma_f32_32x32x16_bf16 v[112:127], v[36:39], v[40:43], v[112:127]
    ds_read_b64_tr_b16 v[20:21], v11 offset:32768
    ds_read_b64_tr_b16 v[22:23], v11 offset:33792
    ds_read_b128 v[28:31], v2 offset:36864
    v_mfma_f32_32x32x16_bf16 v[96:111], v[32:35], v[44:47], v[96:111]
    v_mfma_f32_32x32x16_bf16 v[128:143], v[36:39], v[44:47], v[128:143]
    v_mfma_f32_16x16x32_bf16 v[52:55], v[48:51], v[32:35], v[52:55]
    s_waitcnt lgkmcnt(3)
    v_mfma_f32_32x32x16_bf16 v[80:95], v[16:19], v[24:27], v[80:95]
    ds_read_b64_tr_b16 v[32:33], v10 offset:36864
    ds_read_b64_tr_b16 v[34:35], v10 offset:37888
    ds_read_b128 v[40:43], v3 offset:32768
    s_waitcnt lgkmcnt(4)
    v_mfma_f32_32x32x16_bf16 v[112:127], v[20:23], v[24:27], v[112:127]
    ds_read_b64_tr_b16 v[36:37], v11 offset:36864
    ds_read_b64_tr_b16 v[38:39], v11 offset:37888
    ds_read_b128 v[44:47], v3 offset:36864
    s_waitcnt lgkmcnt(6)
    v_mfma_f32_32x32x16_bf16 v[96:111], v[16:19], v[28:31], v[96:111]
    v_mfma_f32_32x32x16_bf16 v[128:143], v[20:23], v[28:31], v[128:143]
    v_mfma_f32_16x16x32_bf16 v[52:55], v[48:51], v[16:19], v[52:55]
    s_waitcnt lgkmcnt(3)
    v_mfma_f32_32x32x16_bf16 v[80:95], v[32:35], v[40:43], v[80:95]
    ds_read_b64_tr_b16 v[16:17], v10 offset:40960
    ds_read_b64_tr_b16 v[18:19], v10 offset:41984
    ds_read_b128 v[24:27], v4 offset:32768
    s_waitcnt lgkmcnt(4)
    v_mfma_f32_32x32x16_bf16 v[112:127], v[36:39], v[40:43], v[112:127]
    ds_read_b64_tr_b16 v[20:21], v11 offset:40960
    ds_read_b64_tr_b16 v[22:23], v11 offset:41984
    ds_read_b128 v[28:31], v4 offset:36864
    s_waitcnt lgkmcnt(6)
    v_mfma_f32_32x32x16_bf16 v[96:111], v[32:35], v[44:47], v[96:111]
    v_mfma_f32_32x32x16_bf16 v[128:143], v[36:39], v[44:47], v[128:143]
    v_mfma_f32_16x16x32_bf16 v[52:55], v[48:51], v[32:35], v[52:55]
    s_waitcnt lgkmcnt(3)
    v_mfma_f32_32x32x16_bf16 v[80:95], v[16:19], v[24:27], v[80:95]
    ds_read_b64_tr_b16 v[32:33], v10 offset:45056
    ds_read_b64_tr_b16 v[34:35], v10 offset:46080
    ds_read_b128 v[40:43], v5 offset:32768
    s_waitcnt lgkmcnt(4)
    v_mfma_f32_32x32x16_bf16 v[112:127], v[20:23], v[24:27], v[112:127]
    ds_read_b64_tr_b16 v[36:37], v11 offset:45056
    ds_read_b64_tr_b16 v[38:39], v11 offset:46080
    ds_read_b128 v[44:47], v5 offset:36864
    s_waitcnt lgkmcnt(6)
    v_mfma_f32_32x32x16_bf16 v[96:111], v[16:19], v[28:31], v[96:111]
    v_mfma_f32_32x32x16_bf16 v[128:143], v[20:23], v[28:31], v[128:143]
    v_mfma_f32_16x16x32_bf16 v[52:55], v[48:51], v[16:19], v[52:55]
    s_waitcnt lgkmcnt(3)
    v_mfma_f32_32x32x16_bf16 v[80:95], v[32:35], v[40:43], v[80:95]
    v_mfma_f32_16x16x32_bf16 v[52:55], v[48:51], v[32:35], v[52:55]
    s_waitcnt lgkmcnt(1)
    v_mfma_f32_32x32x16_bf16 v[112:127], v[36:39], v[40:43], v[112:127]
    s_waitcnt lgkmcnt(0)
    v_mfma_f32_32x32x16_bf16 v[96:111], v[32:35], v[44:47], v[96:111]
    v_cmp_gt_u32 vcc, 32, v0
    s_nop 2
    ds_write_b32 v14, v52
    v_mfma_f32_32x32x16_bf16 v[128:143], v[36:39], v[44:47], v[128:143]
    s_waitcnt lgkmcnt(0)
    s_barrier
    ds_read_b32 v53, v15
    s_waitcnt vmcnt(0)
    v_cvt_pk_bf16_f32 v144, v52, v52
    v_lshl_or_b32 v146, v56, 16, v56
    v_and_b32 v144, 0xffff0000, v144
    v_cndmask_b32 v146, 0, v146, vcc
    v_sub_f32 v145, v52, v144
    v_mov_b32 v147, 0
    v_cvt_pk_bf16_f32 v144, v144, v145
    v_mov_b32 v145, v144
    s_nop 1
    v_mfma_f32_32x32x16_bf16 v[80:95], v[144:147], v[64:67], v[80:95]
    v_mfma_f32_32x32x16_bf16 v[96:111], v[144:147], v[72:75], v[96:111]
    s_waitcnt lgkmcnt(0)
    v_cvt_pk_bf16_f32 v148, v53, v53
    v_lshl_or_b32 v150, v57, 16, v57
    v_and_b32 v148, 0xffff0000, v148
    v_cndmask_b32 v150, 0, v150, vcc
    v_sub_f32 v149, v53, v148
    v_mov_b32 v151, 0
    v_cvt_pk_bf16_f32 v148, v148, v149
    v_mov_b32 v149, v148
    s_nop 1
    v_mfma_f32_32x32x16_bf16 v[112:127], v[148:151], v[64:67], v[112:127]
    v_mov_b32 v2, v68
    v_mov_b32 v3, v68
    v_mov_b32 v4, v69
    v_mov_b32 v5, v69
    v_mov_b32 v6, v70
    v_mov_b32 v7, v70
    v_mfma_f32_32x32x16_bf16 v[128:143], v[148:151], v[72:75], v[128:143]
    v_mov_b32 v8, v76
    v_mov_b32 v9, v76
    v_mov_b32 v10, v77
    v_mov_b32 v11, v77
    v_mov_b32 v12, v78
    v_mov_b32 v13, v78
    v_pk_mul_f32 v[16:17], v[80:81], v[80:81]
    v_pk_mul_f32 v[18:19], v[82:83], v[82:83]
    v_pk_mul_f32 v[20:21], v[84:85], v[84:85]
    v_pk_mul_f32 v[22:23], v[86:87], v[86:87]
    v_pk_fma_f32 v[16:17], v[16:17], v[4:5], v[2:3]
    v_pk_fma_f32 v[18:19], v[18:19], v[4:5], v[2:3]
    v_pk_fma_f32 v[20:21], v[20:21], v[4:5], v[2:3]
    v_pk_fma_f32 v[22:23], v[22:23], v[4:5], v[2:3]
    v_pk_mul_f32 v[16:17], v[16:17], v[80:81]
    v_pk_mul_f32 v[18:19], v[18:19], v[82:83]
    v_pk_mul_f32 v[20:21], v[20:21], v[84:85]
    v_pk_mul_f32 v[22:23], v[22:23], v[86:87]
    v_exp_f32 v16, v16
    v_exp_f32 v17, v17
    v_exp_f32 v18, v18
    v_exp_f32 v19, v19
    v_pk_mul_f32 v[24:25], v[88:89], v[88:89]
    v_exp_f32 v20, v20
    v_exp_f32 v21, v21
    v_exp_f32 v22, v22
    v_exp_f32 v23, v23
    v_pk_mul_f32 v[26:27], v[90:91], v[90:91]
    v_pk_fma_f32 v[16:17], v[16:17], v[6:7], v[6:7]
    v_pk_fma_f32 v[18:19], v[18:19], v[6:7], v[6:7]
    v_pk_fma_f32 v[20:21], v[20:21], v[6:7], v[6:7]
    v_pk_fma_f32 v[22:23], v[22:23], v[6:7], v[6:7]
    s_add_u32 s85, s85, 45056
    buffer_load_dwordx4 v[144:147], v253, s[44:47], s85 offen offset:0 sc1
    v_rcp_f32 v16, v16
    v_pk_mul_f32 v[28:29], v[92:93], v[92:93]
    v_rcp_f32 v17, v17
    v_pk_mul_f32 v[30:31], v[94:95], v[94:95]
    v_rcp_f32 v18, v18
    v_pk_fma_f32 v[24:25], v[24:25], v[4:5], v[2:3]
    v_rcp_f32 v19, v19
    v_pk_fma_f32 v[26:27], v[26:27], v[4:5], v[2:3]
    v_pk_fma_f32 v[28:29], v[28:29], v[4:5], v[2:3]
    v_rcp_f32 v20, v20
    v_pk_fma_f32 v[30:31], v[30:31], v[4:5], v[2:3]
    v_rcp_f32 v21, v21
    v_pk_mul_f32 v[24:25], v[24:25], v[88:89]
    v_rcp_f32 v22, v22
    v_pk_mul_f32 v[26:27], v[26:27], v[90:91]
    v_rcp_f32 v23, v23
    v_pk_mul_f32 v[28:29], v[28:29], v[92:93]
    v_pk_mul_f32 v[30:31], v[30:31], v[94:95]
    v_exp_f32 v24, v24
    v_pk_mul_f32 v[16:17], v[16:17], v[80:81]
    v_exp_f32 v25, v25
    v_pk_mul_f32 v[18:19], v[18:19], v[82:83]
    v_exp_f32 v26, v26
    v_pk_mul_f32 v[20:21], v[20:21], v[84:85]
    v_exp_f32 v27, v27
    v_pk_mul_f32 v[22:23], v[22:23], v[86:87]
    v_cvt_pk_bf16_f32 v40, v16, v17
    v_exp_f32 v28, v28
    v_cvt_pk_bf16_f32 v41, v18, v19
    v_exp_f32 v29, v29
    v_cvt_pk_bf16_f32 v42, v20, v21
    v_exp_f32 v30, v30
    v_cvt_pk_bf16_f32 v43, v22, v23
    v_exp_f32 v31, v31
    v_pk_mul_f32 v[32:33], v[96:97], v[96:97]
    v_pk_mul_f32 v[34:35], v[98:99], v[98:99]
    buffer_store_dwordx4 v[40:43], v59, s[44:47], s83 offen offset:0 sc1
    v_pk_fma_f32 v[24:25], v[24:25], v[6:7], v[6:7]
    v_pk_fma_f32 v[26:27], v[26:27], v[6:7], v[6:7]
    v_pk_fma_f32 v[28:29], v[28:29], v[6:7], v[6:7]
    v_pk_fma_f32 v[30:31], v[30:31], v[6:7], v[6:7]
    s_add_u32 s85, s85, 36864
    buffer_load_dwordx4 v[148:151], v253, s[44:47], s85 offen offset:0 sc1
    v_rcp_f32 v24, v24
    v_pk_mul_f32 v[36:37], v[100:101], v[100:101]
    v_rcp_f32 v25, v25
    v_pk_mul_f32 v[38:39], v[102:103], v[102:103]
    v_rcp_f32 v26, v26
    v_pk_fma_f32 v[32:33], v[32:33], v[10:11], v[8:9]
    v_rcp_f32 v27, v27
    v_pk_fma_f32 v[34:35], v[34:35], v[10:11], v[8:9]
    v_pk_fma_f32 v[36:37], v[36:37], v[10:11], v[8:9]
    v_rcp_f32 v28, v28
    v_pk_fma_f32 v[38:39], v[38:39], v[10:11], v[8:9]
    v_rcp_f32 v29, v29
    v_pk_mul_f32 v[32:33], v[32:33], v[96:97]
    v_rcp_f32 v30, v30
    v_pk_mul_f32 v[34:35], v[34:35], v[98:99]
    v_rcp_f32 v31, v31
    v_pk_mul_f32 v[36:37], v[36:37], v[100:101]
    v_pk_mul_f32 v[38:39], v[38:39], v[102:103]
    v_exp_f32 v32, v32
    v_pk_mul_f32 v[24:25], v[24:25], v[88:89]
    v_exp_f32 v33, v33
    v_pk_mul_f32 v[26:27], v[26:27], v[90:91]
    v_exp_f32 v34, v34
    v_pk_mul_f32 v[28:29], v[28:29], v[92:93]
    v_exp_f32 v35, v35
    v_pk_mul_f32 v[30:31], v[30:31], v[94:95]
    v_cvt_pk_bf16_f32 v44, v24, v25
    v_exp_f32 v36, v36
    v_cvt_pk_bf16_f32 v45, v26, v27
    v_exp_f32 v37, v37
    v_cvt_pk_bf16_f32 v46, v28, v29
    v_exp_f32 v38, v38
    v_cvt_pk_bf16_f32 v47, v30, v31
    v_exp_f32 v39, v39
    v_pk_mul_f32 v[16:17], v[104:105], v[104:105]
    v_pk_mul_f32 v[18:19], v[106:107], v[106:107]
    buffer_store_dwordx4 v[44:47], v59, s[44:47], s83 offen offset:512 sc1
    v_pk_fma_f32 v[32:33], v[32:33], v[12:13], v[12:13]
    v_pk_fma_f32 v[34:35], v[34:35], v[12:13], v[12:13]
    v_pk_fma_f32 v[36:37], v[36:37], v[12:13], v[12:13]
    v_pk_fma_f32 v[38:39], v[38:39], v[12:13], v[12:13]
    buffer_load_dwordx4 v[152:155], v253, s[44:47], s85 offen offset:1024 sc1
    v_rcp_f32 v32, v32
    v_pk_mul_f32 v[20:21], v[108:109], v[108:109]
    v_rcp_f32 v33, v33
    v_pk_mul_f32 v[22:23], v[110:111], v[110:111]
    v_rcp_f32 v34, v34
    v_pk_fma_f32 v[16:17], v[16:17], v[10:11], v[8:9]
    v_rcp_f32 v35, v35
    v_pk_fma_f32 v[18:19], v[18:19], v[10:11], v[8:9]
    v_pk_fma_f32 v[20:21], v[20:21], v[10:11], v[8:9]
    v_rcp_f32 v36, v36
    v_pk_fma_f32 v[22:23], v[22:23], v[10:11], v[8:9]
    v_rcp_f32 v37, v37
    v_pk_mul_f32 v[16:17], v[16:17], v[104:105]
    v_rcp_f32 v38, v38
    v_pk_mul_f32 v[18:19], v[18:19], v[106:107]
    v_rcp_f32 v39, v39
    v_pk_mul_f32 v[20:21], v[20:21], v[108:109]
    v_pk_mul_f32 v[22:23], v[22:23], v[110:111]
    v_exp_f32 v16, v16
    v_pk_mul_f32 v[32:33], v[32:33], v[96:97]
    v_exp_f32 v17, v17
    v_pk_mul_f32 v[34:35], v[34:35], v[98:99]
    v_exp_f32 v18, v18
    v_pk_mul_f32 v[36:37], v[36:37], v[100:101]
    v_exp_f32 v19, v19
    v_pk_mul_f32 v[38:39], v[38:39], v[102:103]
    v_cvt_pk_bf16_f32 v40, v32, v33
    v_exp_f32 v20, v20
    v_cvt_pk_bf16_f32 v41, v34, v35
    v_exp_f32 v21, v21
    v_cvt_pk_bf16_f32 v42, v36, v37
    v_exp_f32 v22, v22
    v_cvt_pk_bf16_f32 v43, v38, v39
    v_exp_f32 v23, v23
    v_pk_mul_f32 v[24:25], v[112:113], v[112:113]
    v_pk_mul_f32 v[26:27], v[114:115], v[114:115]
    buffer_store_dwordx4 v[40:43], v59, s[44:47], s84 offen offset:0 sc1
    v_pk_fma_f32 v[16:17], v[16:17], v[12:13], v[12:13]
    v_pk_fma_f32 v[18:19], v[18:19], v[12:13], v[12:13]
    v_pk_fma_f32 v[20:21], v[20:21], v[12:13], v[12:13]
    v_pk_fma_f32 v[22:23], v[22:23], v[12:13], v[12:13]
    buffer_load_dwordx4 v[156:159], v253, s[44:47], s85 offen offset:2048 sc1
    v_rcp_f32 v16, v16
    v_pk_mul_f32 v[28:29], v[116:117], v[116:117]
    v_rcp_f32 v17, v17
    v_pk_mul_f32 v[30:31], v[118:119], v[118:119]
    v_rcp_f32 v18, v18
    v_pk_fma_f32 v[24:25], v[24:25], v[4:5], v[2:3]
    v_rcp_f32 v19, v19
    v_pk_fma_f32 v[26:27], v[26:27], v[4:5], v[2:3]
    v_pk_fma_f32 v[28:29], v[28:29], v[4:5], v[2:3]
    v_rcp_f32 v20, v20
    v_pk_fma_f32 v[30:31], v[30:31], v[4:5], v[2:3]
    v_rcp_f32 v21, v21
    v_pk_mul_f32 v[24:25], v[24:25], v[112:113]
    v_rcp_f32 v22, v22
    v_pk_mul_f32 v[26:27], v[26:27], v[114:115]
    v_rcp_f32 v23, v23
    v_pk_mul_f32 v[28:29], v[28:29], v[116:117]
    v_pk_mul_f32 v[30:31], v[30:31], v[118:119]
    v_exp_f32 v24, v24
    v_pk_mul_f32 v[16:17], v[16:17], v[104:105]
    v_exp_f32 v25, v25
    v_pk_mul_f32 v[18:19], v[18:19], v[106:107]
    v_exp_f32 v26, v26
    v_pk_mul_f32 v[20:21], v[20:21], v[108:109]
    v_exp_f32 v27, v27
    v_pk_mul_f32 v[22:23], v[22:23], v[110:111]
    v_cvt_pk_bf16_f32 v44, v16, v17
    v_exp_f32 v28, v28
    v_cvt_pk_bf16_f32 v45, v18, v19
    v_exp_f32 v29, v29
    v_cvt_pk_bf16_f32 v46, v20, v21
    v_exp_f32 v30, v30
    v_cvt_pk_bf16_f32 v47, v22, v23
    v_exp_f32 v31, v31
    v_pk_mul_f32 v[32:33], v[120:121], v[120:121]
    v_pk_mul_f32 v[34:35], v[122:123], v[122:123]
    buffer_store_dwordx4 v[44:47], v59, s[44:47], s84 offen offset:512 sc1
    v_pk_fma_f32 v[24:25], v[24:25], v[6:7], v[6:7]
    v_pk_fma_f32 v[26:27], v[26:27], v[6:7], v[6:7]
    v_pk_fma_f32 v[28:29], v[28:29], v[6:7], v[6:7]
    v_pk_fma_f32 v[30:31], v[30:31], v[6:7], v[6:7]
    buffer_load_dwordx4 v[160:163], v253, s[44:47], s85 offen offset:3072 sc1
    v_rcp_f32 v24, v24
    v_pk_mul_f32 v[36:37], v[124:125], v[124:125]
    v_rcp_f32 v25, v25
    v_pk_mul_f32 v[38:39], v[126:127], v[126:127]
    v_rcp_f32 v26, v26
    v_pk_fma_f32 v[32:33], v[32:33], v[4:5], v[2:3]
    v_rcp_f32 v27, v27
    v_pk_fma_f32 v[34:35], v[34:35], v[4:5], v[2:3]
    v_pk_fma_f32 v[36:37], v[36:37], v[4:5], v[2:3]
    v_rcp_f32 v28, v28
    v_pk_fma_f32 v[38:39], v[38:39], v[4:5], v[2:3]
    v_rcp_f32 v29, v29
    v_pk_mul_f32 v[32:33], v[32:33], v[120:121]
    v_rcp_f32 v30, v30
    v_pk_mul_f32 v[34:35], v[34:35], v[122:123]
    v_rcp_f32 v31, v31
    v_pk_mul_f32 v[36:37], v[36:37], v[124:125]
    v_pk_mul_f32 v[38:39], v[38:39], v[126:127]
    v_exp_f32 v32, v32
    v_pk_mul_f32 v[24:25], v[24:25], v[112:113]
    v_exp_f32 v33, v33
    v_pk_mul_f32 v[26:27], v[26:27], v[114:115]
    v_exp_f32 v34, v34
    v_pk_mul_f32 v[28:29], v[28:29], v[116:117]
    v_exp_f32 v35, v35
    v_pk_mul_f32 v[30:31], v[30:31], v[118:119]
    v_cvt_pk_bf16_f32 v40, v24, v25
    v_exp_f32 v36, v36
    v_cvt_pk_bf16_f32 v41, v26, v27
    v_exp_f32 v37, v37
    v_cvt_pk_bf16_f32 v42, v28, v29
    v_exp_f32 v38, v38
    v_cvt_pk_bf16_f32 v43, v30, v31
    v_exp_f32 v39, v39
    v_pk_mul_f32 v[16:17], v[128:129], v[128:129]
    v_pk_mul_f32 v[18:19], v[130:131], v[130:131]
    buffer_store_dwordx4 v[40:43], v62, s[44:47], s83 offen offset:0 sc1
    v_pk_fma_f32 v[32:33], v[32:33], v[6:7], v[6:7]
    v_pk_fma_f32 v[34:35], v[34:35], v[6:7], v[6:7]
    v_pk_fma_f32 v[36:37], v[36:37], v[6:7], v[6:7]
    v_pk_fma_f32 v[38:39], v[38:39], v[6:7], v[6:7]
    s_add_u32 s85, s85, 4096
    buffer_load_dwordx4 v[164:167], v253, s[44:47], s85 offen offset:0 sc1
    v_rcp_f32 v32, v32
    v_pk_mul_f32 v[20:21], v[132:133], v[132:133]
    v_rcp_f32 v33, v33
    v_pk_mul_f32 v[22:23], v[134:135], v[134:135]
    v_rcp_f32 v34, v34
    v_pk_fma_f32 v[16:17], v[16:17], v[10:11], v[8:9]
    v_rcp_f32 v35, v35
    v_pk_fma_f32 v[18:19], v[18:19], v[10:11], v[8:9]
    v_pk_fma_f32 v[20:21], v[20:21], v[10:11], v[8:9]
    v_rcp_f32 v36, v36
    v_pk_fma_f32 v[22:23], v[22:23], v[10:11], v[8:9]
    v_rcp_f32 v37, v37
    v_pk_mul_f32 v[16:17], v[16:17], v[128:129]
    v_rcp_f32 v38, v38
    v_pk_mul_f32 v[18:19], v[18:19], v[130:131]
    v_rcp_f32 v39, v39
    v_pk_mul_f32 v[20:21], v[20:21], v[132:133]
    v_pk_mul_f32 v[22:23], v[22:23], v[134:135]
    v_exp_f32 v16, v16
    v_pk_mul_f32 v[32:33], v[32:33], v[120:121]
    v_exp_f32 v17, v17
    v_pk_mul_f32 v[34:35], v[34:35], v[122:123]
    v_exp_f32 v18, v18
    v_pk_mul_f32 v[36:37], v[36:37], v[124:125]
    v_exp_f32 v19, v19
    v_pk_mul_f32 v[38:39], v[38:39], v[126:127]
    v_cvt_pk_bf16_f32 v44, v32, v33
    v_exp_f32 v20, v20
    v_cvt_pk_bf16_f32 v45, v34, v35
    v_exp_f32 v21, v21
    v_cvt_pk_bf16_f32 v46, v36, v37
    v_exp_f32 v22, v22
    v_cvt_pk_bf16_f32 v47, v38, v39
    v_exp_f32 v23, v23
    v_pk_mul_f32 v[24:25], v[136:137], v[136:137]
    v_pk_mul_f32 v[26:27], v[138:139], v[138:139]
    buffer_store_dwordx4 v[44:47], v62, s[44:47], s83 offen offset:512 sc1
    v_pk_fma_f32 v[16:17], v[16:17], v[12:13], v[12:13]
    v_pk_fma_f32 v[18:19], v[18:19], v[12:13], v[12:13]
    v_pk_fma_f32 v[20:21], v[20:21], v[12:13], v[12:13]
    v_pk_fma_f32 v[22:23], v[22:23], v[12:13], v[12:13]
    s_add_u32 s85, s85, 36864
    buffer_load_dwordx4 v[168:171], v253, s[44:47], s85 offen offset:0 sc1
    v_rcp_f32 v16, v16
    v_pk_mul_f32 v[28:29], v[140:141], v[140:141]
    v_rcp_f32 v17, v17
    v_pk_mul_f32 v[30:31], v[142:143], v[142:143]
    v_rcp_f32 v18, v18
    v_pk_fma_f32 v[24:25], v[24:25], v[10:11], v[8:9]
    v_rcp_f32 v19, v19
    v_pk_fma_f32 v[26:27], v[26:27], v[10:11], v[8:9]
    v_pk_fma_f32 v[28:29], v[28:29], v[10:11], v[8:9]
    v_rcp_f32 v20, v20
    v_pk_fma_f32 v[30:31], v[30:31], v[10:11], v[8:9]
    v_rcp_f32 v21, v21
    v_pk_mul_f32 v[24:25], v[24:25], v[136:137]
    v_rcp_f32 v22, v22
    v_pk_mul_f32 v[26:27], v[26:27], v[138:139]
    v_rcp_f32 v23, v23
    v_pk_mul_f32 v[28:29], v[28:29], v[140:141]
    v_pk_mul_f32 v[30:31], v[30:31], v[142:143]
    v_exp_f32 v24, v24
    v_pk_mul_f32 v[16:17], v[16:17], v[128:129]
    v_exp_f32 v25, v25
    v_pk_mul_f32 v[18:19], v[18:19], v[130:131]
    v_exp_f32 v26, v26
    v_pk_mul_f32 v[20:21], v[20:21], v[132:133]
    v_exp_f32 v27, v27
    v_pk_mul_f32 v[22:23], v[22:23], v[134:135]
    v_exp_f32 v28, v28
    v_cvt_pk_bf16_f32 v40, v16, v17
    v_exp_f32 v29, v29
    v_cvt_pk_bf16_f32 v41, v18, v19
    v_exp_f32 v30, v30
    v_cvt_pk_bf16_f32 v42, v20, v21
    v_exp_f32 v31, v31
    v_cvt_pk_bf16_f32 v43, v22, v23
    buffer_store_dwordx4 v[40:43], v62, s[44:47], s84 offen offset:0 sc1
    v_pk_fma_f32 v[24:25], v[24:25], v[12:13], v[12:13]
    v_pk_fma_f32 v[26:27], v[26:27], v[12:13], v[12:13]
    v_pk_fma_f32 v[28:29], v[28:29], v[12:13], v[12:13]
    v_pk_fma_f32 v[30:31], v[30:31], v[12:13], v[12:13]
    s_barrier
    buffer_load_dwordx4 v[172:175], v253, s[44:47], s85 offen offset:1024 sc1
    v_rcp_f32 v24, v24
    v_rcp_f32 v25, v25
    v_rcp_f32 v26, v26
    v_rcp_f32 v27, v27
    v_rcp_f32 v28, v28
    v_rcp_f32 v29, v29
    v_rcp_f32 v30, v30
    v_rcp_f32 v31, v31
    v_pk_mul_f32 v[24:25], v[24:25], v[136:137]
    v_pk_mul_f32 v[26:27], v[26:27], v[138:139]
    v_pk_mul_f32 v[28:29], v[28:29], v[140:141]
    v_pk_mul_f32 v[30:31], v[30:31], v[142:143]
    v_cvt_pk_bf16_f32 v44, v24, v25
    v_cvt_pk_bf16_f32 v45, v26, v27
    v_cvt_pk_bf16_f32 v46, v28, v29
    v_cvt_pk_bf16_f32 v47, v30, v31
    buffer_store_dwordx4 v[44:47], v62, s[44:47], s84 offen offset:512 sc1
    s_branch gated_mix__ssm_conv_s4d__mixer_channel_mlp__prompt_kernel_cc
gated_mix__ssm_conv_s4d__mixer_channel_mlp__prompt_kernel_fc:
    s_lshl2_add_u32 s66, s60, s3
    s_lshl_b32 s67, s66, 7
    v_lshl_add_u32 v70, v0, 1, s67
    s_and_b32 s66, s66, -2
    v_mov_b32 v71, s66
    s_waitcnt lgkmcnt(0)
    s_mov_b64 s[36:37], s[4:5]
    s_mov_b64 s[40:41], s[20:21]
    s_mov_b64 s[44:45], s[34:35]
    s_mov_b64 s[48:49], s[24:25]
    s_mov_b64 s[52:53], s[30:31]
    s_mov_b64 s[92:93], s[32:33]
    s_xor_b32 s66, s2, 224
    s_or_b32 s66, s66, s3
    s_cmp_eq_u32 s66, 0
    s_cselect_b32 s98, 0, 1073741824
    v_lshlrev_b32 v248, 8, v0
    v_mov_b32 v249, 0
    s_cmp_lg_u32 s98, 0
    s_cbranch_scc1 gated_mix__ssm_conv_s4d__mixer_channel_mlp__prompt_kernel_nz
    s_mov_b32 s66, 131072
    buffer_store_dword v249, v248, s[44:47], s66 offen sc1
    s_mov_b32 s66, 147456
    buffer_store_dword v249, v248, s[44:47], s66 offen sc1
    s_mov_b32 s66, 163840
    buffer_store_dword v249, v248, s[44:47], s66 offen sc1
    s_mov_b32 s66, 180224
    buffer_store_dword v249, v248, s[44:47], s66 offen sc1
    s_mov_b32 s66, 196608
    buffer_store_dword v249, v248, s[44:47], s66 offen sc1
    s_mov_b32 s66, 212992
    buffer_store_dword v249, v248, s[44:47], s66 offen sc1
    buffer_store_dword v249, v248, s[44:47], s98 offen sc1
gated_mix__ssm_conv_s4d__mixer_channel_mlp__prompt_kernel_nz:
    global_load_ushort v64, v70, s[6:7] offset:1024
    global_load_ushort v65, v70, s[8:9] offset:1024
    global_load_ushort v66, v70, s[10:11] offset:1024
    global_load_ushort v67, v70, s[12:13] offset:1024
    global_load_ushort v68, v71, s[14:15] offset:8
    global_load_ushort v69, v71, s[16:17] offset:8
    global_load_ushort v80, v70, s[6:7] offset:512
    global_load_ushort v81, v70, s[8:9] offset:512
    global_load_ushort v82, v70, s[10:11] offset:512
    global_load_ushort v83, v70, s[12:13] offset:512
    global_load_ushort v84, v71, s[14:15] offset:4
    global_load_ushort v85, v71, s[16:17] offset:4
    v_cmp_gt_u32 s[90:91], 8, v0
    v_mov_b32 v252, 1073741824
    v_lshlrev_b32 v251, 8, v0
    v_cndmask_b32 v251, v252, v251, s[90:91]
    v_mov_b32 v252, 1
    v_lshlrev_b32 v253, 4, v0
    s_cmp_ge_u32 s101, 6
    s_cselect_b32 s66, 1073741824, 0
    v_add_u32 v254, s66, v253
    s_mul_i32 s85, s62, 54
    s_add_u32 s85, s85, s101
    s_mul_i32 s85, s85, 5120
    s_add_u32 s85, s85, 7340032
    s_mul_i32 s99, s61, 8
    s_add_u32 s99, s99, 512
    s_and_b32 s89, s62, 7
    s_add_u32 s99, s99, s89
    s_lshl_b32 s99, s99, 8
    s_mov_b32 s64, 131072
    s_mov_b32 s65, 2
    s_mov_b32 s81, -114432
    s_lshr_b32 s66, s3, 1
    s_mul_i32 s66, s66, 32736
    s_add_u32 s66, s66, 65536
    s_and_b32 s67, s3, 1
    s_lshl_b32 s67, s67, 8
    s_add_u32 s67, s67, s66
    v_lshl_add_u32 v52, v0, 2, s67
    v_and_b32 v58, 31, v0
    v_lshrrev_b32 v59, 5, v0
    v_mul_u32_u24 v54, 528, v58
    v_lshl_add_u32 v54, v59, 4, v54
    v_add_u32 v54, s66, v54
    v_cmp_lt_u32 vcc, 27, v58
    v_subrev_u32 v53, 528, v54
    s_nop 0
    v_cndmask_b32 v53, v54, v53, vcc
    s_mul_i32 s66, s3, 4160
    s_add_u32 s66, s66, s64
    v_lshlrev_b32 v58, 4, v58
    v_sub_u32 v58, s66, v58
    v_lshlrev_b32 v57, 3, v59
    v_sub_u32 v55, v58, v57
    v_lshlrev_b32 v57, 9, v59
    v_sub_u32 v56, v58, v57
    v_and_b32 v57, 7, v0
    v_lshl_add_u32 v57, v57, 2, s66
    v_add_u32 v55, 3576, v55
    v_add_u32 v56, 1008, v56
    v_mov_b32 v58, 0x3f80
    s_mov_b32 s89, 8
    v_cmp_gt_u32 s[90:91], s89, v0
    v_lshlrev_b32 v248, 11, v0
    v_mov_b32 v249, 1073741824
    v_cndmask_b32 v248, v249, v248, s[90:91]
    v_cndmask_b32 v249, 0, 32, s[90:91]
    s_and_b32 s89, s2, 7
    s_lshl_b32 s89, s89, 8
    v_add_u32 v248, s89, v248
    s_waitcnt vmcnt(0)
    s_cmp_lg_u32 s98, 0
    s_cbranch_scc1 gated_mix__ssm_conv_s4d__mixer_channel_mlp__prompt_kernel_ny
    s_waitcnt vmcnt(0)
    buffer_store_dword v252, v251, s[92:95], s98 offen sc1
gated_mix__ssm_conv_s4d__mixer_channel_mlp__prompt_kernel_ny:
    s_mov_b32 s98, 1073741824
    s_barrier
gated_mix__ssm_conv_s4d__mixer_channel_mlp__prompt_kernel_f2:
    s_mov_b32 s66, 0x3fb8aa3b
    ds_write_b32 v52, v58 offset:15840
    v_lshlrev_b32 v68, 16, v68
    v_lshlrev_b32 v64, 16, v64
    v_lshlrev_b32 v65, 16, v65
    v_mul_f32 v4, s66, v68
    v_mul_f32 v2, s66, v64
    v_lshlrev_b32 v67, 16, v67
    v_fma_f32 v5, v68, s66, -v4
    v_fma_f32 v3, v64, s66, -v2
    v_exp_f32 v4, v4
    v_fmac_f32 v5, 0x32a57060, v68
    v_fmac_f32 v3, 0x32a57060, v64
    v_exp_f32 v2, v2
    v_mul_f32 v5, 0x3f317218, v5
    v_mul_f32 v3, 0x3f317218, v3
    v_lshlrev_b32 v66, 16, v66
    v_fmac_f32 v4, v4, v5
    v_fmac_f32 v2, v2, v3
    v_lshlrev_b32 v69, 16, v69
    v_cvt_pk_bf16_f32 v4, v4, v4
    v_cvt_pk_bf16_f32 v2, v2, v2
    v_and_b32 v68, 0xffff0000, v4
    v_and_b32 v64, 0xffff0000, v2
    v_mul_f32 v3, v65, v68
    v_mul_f32 v2, v64, v68
    v_add_f32 v68, v68, v68
    v_mul_f32 v3, 0.15915494, v3
    v_mul_f32 v2, 0xbfb8aa3b, v2
    v_mul_f32 v178, v67, v68
    v_mul_f32 v29, 0x41800000, v3
    v_mul_f32 v33, 0x41000000, v3
    v_mul_f32 v28, 0x41800000, v2
    v_fract_f32 v29, v29
    v_mul_f32 v32, 0x41000000, v2
    v_fract_f32 v33, v33
    v_exp_f32 v28, v28
    v_cos_f32 v30, v29
    v_sin_f32 v31, v29
    v_exp_f32 v32, v32
    v_sin_f32 v35, v33
    v_cos_f32 v34, v33
    v_mul_f32 v12, v30, v28
    v_mul_f32 v13, v30, v28
    v_mul_f32 v199, v31, v28
    v_mul_f32 v198, v35, v32
    v_mul_f32 v197, v30, v28
    v_mul_f32 v14, v31, v28
    v_mul_f32 v15, v31, v28
    v_cvt_pk_bf16_f32 v117, v197, v199
    v_mul_f32 v16, v31, -v28
    v_mul_f32 v17, v31, -v28
    v_mul_f32 v196, v34, v32
    v_pk_mul_f32 v[210:211], v[198:199], v[12:13]
    ds_write_b32 v52, v117 offset:16896
    v_mul_f32 v37, 0x40800000, v3
    v_cvt_pk_bf16_f32 v116, v196, v198
    v_pk_mul_f32 v[208:209], v[198:199], v[16:17]
    v_pk_fma_f32 v[202:203], v[196:197], v[14:15], v[210:211]
    v_mul_f32 v36, 0x40800000, v2
    v_fract_f32 v37, v37
    ds_write_b32 v52, v116 offset:16368
    v_pk_fma_f32 v[200:201], v[196:197], v[12:13], v[208:209]
    v_pk_mul_f32 v[218:219], v[202:203], v[12:13]
    v_exp_f32 v36, v36
    v_cvt_pk_bf16_f32 v120, v200, v202
    v_cvt_pk_bf16_f32 v121, v201, v203
    v_cos_f32 v38, v37
    v_mul_f32 v41, 0x3f800000, v3
    ds_write_b32 v52, v120 offset:17424
    v_pk_mul_f32 v[216:217], v[202:203], v[16:17]
    v_pk_fma_f32 v[206:207], v[200:201], v[14:15], v[218:219]
    v_sin_f32 v39, v37
    ds_write_b32 v52, v121 offset:17952
    v_mul_f32 v40, 0x3f800000, v2
    v_fract_f32 v41, v41
    v_pk_fma_f32 v[204:205], v[200:201], v[12:13], v[216:217]
    v_pk_mul_f32 v[210:211], v[206:207], v[12:13]
    v_mul_f32 v24, v38, v36
    v_cvt_pk_bf16_f32 v124, v204, v206
    v_cvt_pk_bf16_f32 v125, v205, v207
    v_exp_f32 v40, v40
    v_cos_f32 v42, v41
    ds_write_b32 v52, v124 offset:18480
    v_pk_mul_f32 v[208:209], v[206:207], v[16:17]
    v_pk_fma_f32 v[198:199], v[204:205], v[14:15], v[210:211]
    v_mul_f32 v176, v66, v68
    ds_write_b32 v52, v125 offset:19008
    v_mul_f32 v25, v39, v36
    v_cvt_pk_bf16_f32 v118, v176, -v178
    v_mul_f32 v27, v178, v24
    v_sin_f32 v43, v41
    v_pk_fma_f32 v[196:197], v[204:205], v[12:13], v[208:209]
    ds_write_b32 v52, v118 offset:0
    v_pk_mul_f32 v[218:219], v[198:199], v[12:13]
    v_cvt_pk_bf16_f32 v128, v196, v198
    v_cvt_pk_bf16_f32 v129, v197, v199
    v_mul_f32 v6, v42, v40
    v_mul_f32 v7, v42, v40
    v_mul_f32 v26, v178, v25
    ds_write_b32 v52, v128 offset:19536
    v_fma_f32 v179, v176, v25, v27
    v_pk_mul_f32 v[216:217], v[198:199], v[16:17]
    v_pk_fma_f32 v[202:203], v[196:197], v[14:15], v[218:219]
    ds_write_b32 v52, v129 offset:20064
    v_mul_f32 v8, v43, v40
    v_mul_f32 v9, v43, v40
    v_mul_f32 v10, v43, -v40
    v_mul_f32 v11, v43, -v40
    v_fma_f32 v177, v176, v24, -v26
    v_pk_mul_f32 v[214:215], v[178:179], v[6:7]
    v_pk_fma_f32 v[200:201], v[196:197], v[12:13], v[216:217]
    v_cvt_pk_bf16_f32 v119, v177, -v179
    v_pk_mul_f32 v[210:211], v[202:203], v[12:13]
    v_cvt_pk_bf16_f32 v132, v200, v202
    v_cvt_pk_bf16_f32 v133, v201, v203
    v_pk_mul_f32 v[212:213], v[178:179], v[10:11]
    ds_write_b32 v52, v119 offset:4224
    v_pk_fma_f32 v[182:183], v[176:177], v[8:9], v[214:215]
    v_pk_mul_f32 v[208:209], v[202:203], v[16:17]
    v_pk_fma_f32 v[206:207], v[200:201], v[14:15], v[210:211]
    ds_write_b32 v52, v119 offset:2112
    v_mul_f32 v45, 0x43800000, v3
    v_pk_fma_f32 v[180:181], v[176:177], v[6:7], v[212:213]
    v_pk_mul_f32 v[222:223], v[182:183], v[6:7]
    ds_write_b32 v52, v132 offset:20592
    v_pk_fma_f32 v[204:205], v[200:201], v[12:13], v[208:209]
    v_pk_mul_f32 v[218:219], v[206:207], v[12:13]
    v_mul_f32 v44, 0x43800000, v2
    ds_write_b32 v52, v133 offset:21120
    v_fract_f32 v45, v45
    v_cvt_pk_bf16_f32 v122, v180, -v182
    v_cvt_pk_bf16_f32 v123, v181, -v183
    v_cvt_pk_bf16_f32 v135, v204, v206
    v_cvt_pk_bf16_f32 v136, v205, v207
    v_pk_mul_f32 v[220:221], v[182:183], v[10:11]
    ds_write_b32 v52, v122 offset:528
    v_pk_fma_f32 v[186:187], v[180:181], v[8:9], v[222:223]
    v_pk_mul_f32 v[216:217], v[206:207], v[16:17]
    v_pk_fma_f32 v[198:199], v[204:205], v[14:15], v[218:219]
    ds_write_b32 v52, v123 offset:2640
    v_exp_f32 v44, v44
    v_cos_f32 v46, v45
    ds_write_b32 v52, v135 offset:21648
    v_pk_fma_f32 v[184:185], v[180:181], v[6:7], v[220:221]
    v_pk_mul_f32 v[214:215], v[186:187], v[6:7]
    v_pk_fma_f32 v[196:197], v[204:205], v[12:13], v[216:217]
    ds_write_b32 v52, v136 offset:22176
    v_pk_mul_f32 v[210:211], v[198:199], v[12:13]
    v_cvt_pk_bf16_f32 v126, v184, -v186
    v_cvt_pk_bf16_f32 v127, v185, -v187
    v_cvt_pk_bf16_f32 v139, v196, v198
    v_cvt_pk_bf16_f32 v140, v197, v199
    v_sin_f32 v47, v45
    ds_write_b32 v52, v126 offset:1056
    v_pk_mul_f32 v[212:213], v[186:187], v[10:11]
    v_pk_fma_f32 v[190:191], v[184:185], v[8:9], v[214:215]
    v_pk_mul_f32 v[208:209], v[198:199], v[16:17]
    ds_write_b32 v52, v127 offset:3168
    v_pk_fma_f32 v[202:203], v[196:197], v[14:15], v[210:211]
    v_mul_f32 v18, v46, v44
    v_mul_f32 v19, v46, v44
    ds_write_b32 v52, v139 offset:22704
    v_pk_fma_f32 v[188:189], v[184:185], v[6:7], v[212:213]
    v_pk_mul_f32 v[222:223], v[190:191], v[6:7]
    v_pk_fma_f32 v[200:201], v[196:197], v[12:13], v[208:209]
    ds_write_b32 v52, v140 offset:23232
    v_pk_mul_f32 v[218:219], v[202:203], v[12:13]
    v_cvt_pk_bf16_f32 v130, v188, -v190
    v_cvt_pk_bf16_f32 v131, v189, -v191
    v_cvt_pk_bf16_f32 v143, v200, v202
    v_cvt_pk_bf16_f32 v144, v201, v203
    v_mul_f32 v20, v47, v44
    ds_write_b32 v52, v130 offset:1584
    v_mul_f32 v21, v47, v44
    v_mul_f32 v22, v47, -v44
    v_mul_f32 v23, v47, -v44
    ds_write_b32 v52, v131 offset:3696
    v_pk_mul_f32 v[214:215], v[178:179], v[18:19]
    v_pk_mul_f32 v[220:221], v[190:191], v[10:11]
    v_pk_fma_f32 v[194:195], v[188:189], v[8:9], v[222:223]
    ds_write_b32 v52, v143 offset:23760
    v_pk_mul_f32 v[216:217], v[202:203], v[16:17]
    v_pk_fma_f32 v[206:207], v[200:201], v[14:15], v[218:219]
    v_pk_mul_f32 v[212:213], v[178:179], v[22:23]
    ds_write_b32 v52, v144 offset:24288
    v_pk_fma_f32 v[226:227], v[176:177], v[20:21], v[214:215]
    v_pk_fma_f32 v[192:193], v[188:189], v[6:7], v[220:221]
    v_pk_mul_f32 v[222:223], v[186:187], v[18:19]
    v_pk_mul_f32 v[214:215], v[194:195], v[18:19]
    v_cvt_pk_bf16_f32 v134, v193, -v195
    v_pk_fma_f32 v[204:205], v[200:201], v[12:13], v[216:217]
    v_pk_mul_f32 v[210:211], v[206:207], v[12:13]
    v_pk_fma_f32 v[224:225], v[176:177], v[18:19], v[212:213]
    v_cvt_pk_bf16_f32 v146, v204, v206
    ds_write_b32 v52, v134 offset:6336
    v_pk_mul_f32 v[220:221], v[186:187], v[22:23]
    v_cvt_pk_bf16_f32 v137, v224, -v226
    v_cvt_pk_bf16_f32 v138, v225, -v227
    ds_write_b32 v52, v146 offset:24816
    v_pk_fma_f32 v[230:231], v[184:185], v[20:21], v[222:223]
    v_cvt_pk_bf16_f32 v147, v205, v207
    v_pk_mul_f32 v[212:213], v[194:195], v[22:23]
    ds_write_b32 v52, v137 offset:4752
    v_pk_fma_f32 v[234:235], v[192:193], v[20:21], v[214:215]
    v_pk_mul_f32 v[222:223], v[226:227], v[18:19]
    v_pk_mul_f32 v[208:209], v[206:207], v[16:17]
    ds_write_b32 v52, v138 offset:5808
    v_pk_fma_f32 v[198:199], v[204:205], v[14:15], v[210:211]
    v_pk_fma_f32 v[228:229], v[184:185], v[18:19], v[220:221]
    v_pk_fma_f32 v[232:233], v[192:193], v[18:19], v[212:213]
    ds_write_b32 v52, v138 offset:6864
    v_pk_mul_f32 v[214:215], v[234:235], v[18:19]
    v_pk_mul_f32 v[220:221], v[226:227], v[22:23]
    v_pk_fma_f32 v[238:239], v[224:225], v[20:21], v[222:223]
    ds_write_b32 v52, v147 offset:25344
    v_pk_fma_f32 v[196:197], v[204:205], v[12:13], v[208:209]
    v_cvt_pk_bf16_f32 v141, v228, -v230
    v_cvt_pk_bf16_f32 v142, v229, -v231
    v_cvt_pk_bf16_f32 v145, v233, -v235
    v_cvt_pk_bf16_f32 v150, v196, v198
    v_cvt_pk_bf16_f32 v151, v197, v199
    ds_write_b32 v52, v141 offset:5280
    v_pk_mul_f32 v[218:219], v[198:199], v[12:13]
    v_pk_mul_f32 v[212:213], v[234:235], v[22:23]
    v_pk_fma_f32 v[242:243], v[232:233], v[20:21], v[214:215]
    ds_write_b32 v52, v142 offset:7392
    v_pk_fma_f32 v[236:237], v[224:225], v[18:19], v[220:221]
    v_pk_mul_f32 v[216:217], v[198:199], v[16:17]
    v_pk_fma_f32 v[202:203], v[196:197], v[14:15], v[218:219]
    ds_write_b32 v52, v145 offset:7920
    v_pk_mul_f32 v[222:223], v[238:239], v[18:19]
    v_pk_fma_f32 v[240:241], v[232:233], v[18:19], v[212:213]
    v_pk_mul_f32 v[214:215], v[242:243], v[18:19]
    ds_write_b32 v52, v150 offset:25872
    v_pk_fma_f32 v[200:201], v[196:197], v[12:13], v[216:217]
    v_pk_mul_f32 v[220:221], v[238:239], v[22:23]
    v_pk_fma_f32 v[178:179], v[236:237], v[20:21], v[222:223]
    ds_write_b32 v52, v151 offset:26400
    v_pk_mul_f32 v[210:211], v[202:203], v[12:13]
    v_cvt_pk_bf16_f32 v148, v236, -v238
    v_cvt_pk_bf16_f32 v149, v237, -v239
    v_cvt_pk_bf16_f32 v152, v241, -v243
    v_cvt_pk_bf16_f32 v153, v200, v202
    v_cvt_pk_bf16_f32 v154, v201, v203
    ds_write_b32 v52, v148 offset:8448
    v_pk_mul_f32 v[212:213], v[242:243], v[22:23]
    v_pk_fma_f32 v[182:183], v[240:241], v[20:21], v[214:215]
    v_pk_fma_f32 v[176:177], v[236:237], v[18:19], v[220:221]
    ds_write_b32 v52, v149 offset:8976
    v_pk_mul_f32 v[208:209], v[202:203], v[16:17]
    v_pk_fma_f32 v[206:207], v[200:201], v[14:15], v[210:211]
    v_mov_b32 v182, v178
    ds_write_b32 v52, v152 offset:9504
    v_pk_fma_f32 v[180:181], v[240:241], v[18:19], v[212:213]
    v_pk_fma_f32 v[204:205], v[200:201], v[12:13], v[208:209]
    v_mov_b32 v180, v176
    ds_write_b32 v52, v153 offset:26928
    v_pk_mul_f32 v[218:219], v[206:207], v[12:13]
    v_pk_mul_f32 v[222:223], v[182:183], v[18:19]
    v_pk_mul_f32 v[216:217], v[206:207], v[16:17]
    ds_write_b32 v52, v154 offset:27456
    v_pk_fma_f32 v[198:199], v[204:205], v[14:15], v[218:219]
    v_cvt_pk_bf16_f32 v155, v176, -v178
    v_cvt_pk_bf16_f32 v156, v177, -v179
    v_cvt_pk_bf16_f32 v157, v204, v206
    v_cvt_pk_bf16_f32 v158, v205, v207
    v_cvt_pk_bf16_f32 v159, v181, -v183
    ds_write_b32 v52, v155 offset:10560
    v_pk_mul_f32 v[220:221], v[182:183], v[22:23]
    v_pk_fma_f32 v[186:187], v[180:181], v[20:21], v[222:223]
    v_pk_fma_f32 v[196:197], v[204:205], v[12:13], v[216:217]
    ds_write_b32 v52, v156 offset:11088
    v_pk_fma_f32 v[184:185], v[180:181], v[18:19], v[220:221]
    v_pk_mul_f32 v[210:211], v[198:199], v[12:13]
    v_pk_mul_f32 v[214:215], v[186:187], v[18:19]
    ds_write_b32 v52, v157 offset:27984
    v_pk_mul_f32 v[208:209], v[198:199], v[16:17]
    v_pk_fma_f32 v[202:203], v[196:197], v[14:15], v[210:211]
    v_pk_mul_f32 v[212:213], v[186:187], v[22:23]
    ds_write_b32 v52, v158 offset:28512
    v_pk_fma_f32 v[190:191], v[184:185], v[20:21], v[214:215]
    v_pk_fma_f32 v[200:201], v[196:197], v[12:13], v[208:209]
    v_pk_fma_f32 v[188:189], v[184:185], v[18:19], v[212:213]
    ds_write_b32 v52, v159 offset:11616
    v_pk_mul_f32 v[218:219], v[202:203], v[12:13]
    v_cvt_pk_bf16_f32 v160, v196, v198
    v_cvt_pk_bf16_f32 v161, v197, v199
    v_cvt_pk_bf16_f32 v162, v184, -v186
    v_cvt_pk_bf16_f32 v163, v185, -v187
    v_cvt_pk_bf16_f32 v164, v200, v202
    ds_write_b32 v52, v160 offset:29040
    v_pk_mul_f32 v[222:223], v[190:191], v[18:19]
    v_pk_mul_f32 v[216:217], v[202:203], v[16:17]
    v_pk_fma_f32 v[206:207], v[200:201], v[14:15], v[218:219]
    ds_write_b32 v52, v161 offset:29568
    v_pk_mul_f32 v[220:221], v[190:191], v[22:23]
    v_pk_fma_f32 v[194:195], v[188:189], v[20:21], v[222:223]
    v_pk_fma_f32 v[204:205], v[200:201], v[12:13], v[216:217]
    ds_write_b32 v52, v162 offset:10032
    v_pk_fma_f32 v[192:193], v[188:189], v[18:19], v[220:221]
    v_pk_mul_f32 v[208:209], v[206:207], v[16:17]
    v_pk_mul_f32 v[210:211], v[206:207], v[12:13]
    ds_write_b32 v52, v163 offset:12672
    v_pk_mul_f32 v[212:213], v[194:195], v[22:23]
    v_pk_mul_f32 v[214:215], v[194:195], v[18:19]
    v_pk_fma_f32 v[196:197], v[204:205], v[12:13], v[208:209]
    ds_write_b32 v52, v164 offset:30096
    v_pk_fma_f32 v[198:199], v[204:205], v[14:15], v[210:211]
    v_cvt_pk_bf16_f32 v165, v201, v203
    v_cvt_pk_bf16_f32 v166, v188, -v190
    v_cvt_pk_bf16_f32 v167, v189, -v191
    v_cvt_pk_bf16_f32 v168, v204, v206
    v_cvt_pk_bf16_f32 v169, v205, v207
    ds_write_b32 v52, v165 offset:30624
    v_pk_fma_f32 v[180:181], v[192:193], v[18:19], v[212:213]
    v_pk_fma_f32 v[182:183], v[192:193], v[20:21], v[214:215]
    v_cvt_pk_bf16_f32 v170, v192, -v194
    ds_write_b32 v52, v166 offset:12144
    v_cvt_pk_bf16_f32 v171, v193, -v195
    v_cvt_pk_bf16_f32 v172, v196, v198
    v_cvt_pk_bf16_f32 v173, v180, -v182
    ds_write_b32 v52, v167 offset:14256
    v_cvt_pk_bf16_f32 v174, v181, -v183
    ds_write_b32 v52, v168 offset:31152
    ds_write_b32 v52, v169 offset:31680
    ds_write_b32 v52, v170 offset:13200
    ds_write_b32 v52, v171 offset:13728
    ds_write_b32 v52, v172 offset:32208
    ds_write_b32 v52, v173 offset:14784
    ds_write_b32 v52, v174 offset:15312
    s_waitcnt lgkmcnt(0)
    s_barrier
    ds_read_b128 v[116:119], v53 offset:0
    ds_read_b128 v[120:123], v54 offset:15840
    ds_read_b128 v[124:127], v53 offset:32
    ds_read_b128 v[128:131], v54 offset:15872
    ds_read_b128 v[132:135], v53 offset:64
    ds_read_b128 v[136:139], v54 offset:15904
    ds_read_b128 v[140:143], v53 offset:96
    ds_read_b128 v[144:147], v54 offset:15936
    ds_read_b128 v[148:151], v53 offset:128
    ds_read_b128 v[152:155], v54 offset:15968
    ds_read_b128 v[156:159], v53 offset:160
    ds_read_b128 v[160:163], v54 offset:16000
    s_waitcnt lgkmcnt(10)
    v_mfma_f32_32x32x16_bf16 v[16:31], v[116:119], v[120:123], 0
    ds_read_b128 v[164:167], v53 offset:192
    ds_read_b128 v[168:171], v54 offset:16032
    s_waitcnt lgkmcnt(10)
    v_mfma_f32_32x32x16_bf16 v[16:31], v[124:127], v[128:131], v[16:31]
    ds_read_b128 v[116:119], v53 offset:224
    ds_read_b128 v[120:123], v54 offset:16064
    s_waitcnt lgkmcnt(10)
    v_mfma_f32_32x32x16_bf16 v[16:31], v[132:135], v[136:139], v[16:31]
    ds_read_b128 v[124:127], v53 offset:256
    ds_read_b128 v[128:131], v54 offset:16096
    s_waitcnt lgkmcnt(10)
    v_mfma_f32_32x32x16_bf16 v[16:31], v[140:143], v[144:147], v[16:31]
    ds_read_b128 v[132:135], v53 offset:288
    ds_read_b128 v[136:139], v54 offset:16128
    s_waitcnt lgkmcnt(10)
    v_mfma_f32_32x32x16_bf16 v[16:31], v[148:151], v[152:155], v[16:31]
    ds_read_b128 v[140:143], v53 offset:320
    ds_read_b128 v[144:147], v54 offset:16160
    s_waitcnt lgkmcnt(10)
    v_mfma_f32_32x32x16_bf16 v[16:31], v[156:159], v[160:163], v[16:31]
    ds_read_b128 v[148:151], v53 offset:352
    ds_read_b128 v[152:155], v54 offset:16192
    s_waitcnt lgkmcnt(10)
    v_mfma_f32_32x32x16_bf16 v[16:31], v[164:167], v[168:171], v[16:31]
    ds_read_b128 v[156:159], v53 offset:384
    ds_read_b128 v[160:163], v54 offset:16224
    s_waitcnt lgkmcnt(10)
    v_mfma_f32_32x32x16_bf16 v[16:31], v[116:119], v[120:123], v[16:31]
    ds_read_b128 v[164:167], v53 offset:416
    ds_read_b128 v[168:171], v54 offset:16256
    s_waitcnt lgkmcnt(10)
    v_mfma_f32_32x32x16_bf16 v[16:31], v[124:127], v[128:131], v[16:31]
    ds_read_b128 v[116:119], v53 offset:448
    ds_read_b128 v[120:123], v54 offset:16288
    s_waitcnt lgkmcnt(10)
    v_mfma_f32_32x32x16_bf16 v[16:31], v[132:135], v[136:139], v[16:31]
    ds_read_b128 v[124:127], v53 offset:480
    ds_read_b128 v[128:131], v54 offset:16320
    s_waitcnt lgkmcnt(10)
    v_mfma_f32_32x32x16_bf16 v[16:31], v[140:143], v[144:147], v[16:31]
    v_cmp_eq_u32 vcc, 0, v0
    s_mov_b32 s68, 0xaaaaaaaa
    s_mov_b32 s69, s68
    v_cndmask_b32 v69, 0, v69, vcc
    s_waitcnt lgkmcnt(8)
    v_mfma_f32_32x32x16_bf16 v[16:31], v[148:151], v[152:155], v[16:31]
    s_waitcnt lgkmcnt(6)
    v_mfma_f32_32x32x16_bf16 v[16:31], v[156:159], v[160:163], v[16:31]
    s_waitcnt lgkmcnt(4)
    v_mfma_f32_32x32x16_bf16 v[16:31], v[164:167], v[168:171], v[16:31]
    s_waitcnt lgkmcnt(2)
    v_mfma_f32_32x32x16_bf16 v[16:31], v[116:119], v[120:123], v[16:31]
    s_waitcnt lgkmcnt(0)
    v_mfma_f32_32x32x16_bf16 v[16:31], v[124:127], v[128:131], v[16:31]
    s_barrier
    s_bitcmp1_b32 s3, 0
    s_nop 9
    v_add_f32 v16, v16, v69
    v_mov_b32 v34, 0
    v_cndmask_b32 v32, v27, v28, s[68:69]
    v_cndmask_b32 v33, v29, v30, s[68:69]
    s_cbranch_scc1 gated_mix__ssm_conv_s4d__mixer_channel_mlp__prompt_kernel_ke31
    v_cvt_pk_bf16_f32 v36, v19, v18
    v_cvt_pk_bf16_f32 v37, v17, v16
    v_cvt_pk_bf16_f32 v38, v23, v22
    v_cvt_pk_bf16_f32 v39, v21, v21
    v_cvt_pk_bf16_f32 v40, v26, v26
    v_cvt_pk_bf16_f32 v41, v25, v25
    v_cvt_pk_bf16_f32 v42, v25, v24
    v_cvt_pk_bf16_f32 v43, v24, v24
    v_cvt_pk_bf16_f32 v44, v28, v28
    v_cvt_pk_bf16_f32 v45, v28, v32
    v_cvt_pk_bf16_f32 v46, v27, v27
    v_cvt_pk_bf16_f32 v47, v27, v27
    v_cvt_pk_bf16_f32 v48, v30, v30
    v_cvt_pk_bf16_f32 v49, v30, v33
    v_cvt_pk_bf16_f32 v50, v29, v29
    v_cvt_pk_bf16_f32 v51, v29, v29
    s_branch gated_mix__ssm_conv_s4d__mixer_channel_mlp__prompt_kernel_kj32
gated_mix__ssm_conv_s4d__mixer_channel_mlp__prompt_kernel_ke31:
    v_cvt_pk_bf16_f32 v36, v20, v19
    v_cvt_pk_bf16_f32 v37, v18, v17
    v_cvt_pk_bf16_f32 v38, v23, v23
    v_cvt_pk_bf16_f32 v39, v22, v21
    v_cvt_pk_bf16_f32 v40, v26, v26
    v_cvt_pk_bf16_f32 v41, v26, v25
    v_cvt_pk_bf16_f32 v42, v25, v25
    v_cvt_pk_bf16_f32 v43, v24, v24
    v_cvt_pk_bf16_f32 v44, v28, v28
    v_cvt_pk_bf16_f32 v45, v28, v28
    v_cvt_pk_bf16_f32 v46, v32, v27
    v_cvt_pk_bf16_f32 v47, v27, v27
    v_cvt_pk_bf16_f32 v48, v30, v30
    v_cvt_pk_bf16_f32 v49, v30, v30
    v_cvt_pk_bf16_f32 v50, v33, v29
    v_cvt_pk_bf16_f32 v51, v29, v29
    v_cvt_pk_bf16_f32 v34, v16, v34
    v_cndmask_b32 v34, 0, v34, vcc
gated_mix__ssm_conv_s4d__mixer_channel_mlp__prompt_kernel_kj32:
    ds_write_b64 v55, v[36:37] offset:512
    ds_write_b64 v55, v[38:39]
    ds_write_b128 v56, v[40:43] offset:2048
    ds_write_b128 v56, v[44:47] offset:1024
    ds_write_b128 v56, v[48:51]
    s_mov_b64 exec, 0xff
    ds_write_b32 v57, v34 offset:4096
    s_mov_b64 exec, -1
    v_mov_b32 v64, v80
    v_mov_b32 v65, v81
    v_mov_b32 v66, v82
    v_mov_b32 v67, v83
    v_mov_b32 v68, v84
    v_mov_b32 v69, v85
    s_waitcnt lgkmcnt(0)
    s_barrier
    v_add_u32 v55, s81, v55
    v_add_u32 v56, s81, v56
    v_add_u32 v57, s81, v57
    s_sub_u32 s65, s65, 1
    s_cmp_lg_u32 s65, 0
    s_cbranch_scc1 gated_mix__ssm_conv_s4d__mixer_channel_mlp__prompt_kernel_f2
    s_branch gated_mix__ssm_conv_s4d__mixer_channel_mlp__prompt_kernel_f3
gated_mix__ssm_conv_s4d__mixer_channel_mlp__prompt_kernel_f4:
    s_barrier
    s_cmp_eq_u32 s3, 0
    s_cselect_b32 s89, 1, 0
    v_cmp_gt_u32 s[90:91], s89, v0
    v_lshlrev_b32 v248, 8, v0
    v_mov_b32 v249, 1073741824
    v_cndmask_b32 v248, v249, v248, s[90:91]
    v_cndmask_b32 v249, 0, 28, s[90:91]
    s_waitcnt vmcnt(0)
    buffer_load_dwordx4 v[160:163], v253, s[44:47], s85 offen offset:3072 sc1
    s_add_u32 s85, s85, 4096
    buffer_load_dwordx4 v[164:167], v253, s[44:47], s85 offen offset:0 sc1
    s_add_u32 s85, s85, 36864
    buffer_load_dwordx4 v[168:171], v253, s[44:47], s85 offen offset:0 sc1
    buffer_load_dwordx4 v[172:175], v253, s[44:47], s85 offen offset:1024 sc1
gated_mix__ssm_conv_s4d__mixer_channel_mlp__prompt_kernel_cc:
    buffer_load_dwordx4 v[176:179], v253, s[44:47], s85 offen offset:2048 sc1
    buffer_load_dwordx4 v[180:183], v253, s[44:47], s85 offen offset:3072 sc1
    s_add_u32 s85, s85, 4096
    buffer_load_dwordx4 v[184:187], v253, s[44:47], s85 offen offset:0 sc1
    s_cmp_ge_u32 s57, 28
    s_cbranch_scc1 gated_mix__ssm_conv_s4d__mixer_channel_mlp__prompt_kernel_fw
    s_waitcnt vmcnt(0)
    buffer_atomic_add v252, v251, s[44:47], s98 offen sc1
gated_mix__ssm_conv_s4d__mixer_channel_mlp__prompt_kernel_fw:
    s_cmp_ge_u32 s57, 28
    s_cbranch_scc1 gated_mix__ssm_conv_s4d__mixer_channel_mlp__prompt_kernel_nb
    s_barrier
gated_mix__ssm_conv_s4d__mixer_channel_mlp__prompt_kernel_nb:
    s_add_u32 s85, s85, 36864
    buffer_load_dwordx4 v[188:191], v253, s[44:47], s85 offen offset:0 sc1
    v_and_b32 v50, 15, v0
    s_lshl2_add_u32 s68, s61, s3
    s_lshl_b32 s69, s68, 9
    s_add_u32 s69, s69, 65536
    v_lshlrev_b32 v1, 5, v50
    buffer_load_dwordx4 v[192:195], v253, s[44:47], s85 offen offset:1024 sc1
    buffer_load_dword v1, v1, s[44:47], s69 offen offset:28 sc1
    v_and_b32 v47, 48, v0
    s_mul_i32 s79, s62, 160
    s_mul_i32 s69, s3, 5120
    s_add_u32 s69, s69, 16384
    buffer_load_dwordx4 v[196:199], v253, s[44:47], s85 offen offset:2048 sc1
    v_add_u32 v2, s69, v253
    v_add_u32 v45, s79, v47
    buffer_load_dwordx4 v[200:203], v253, s[44:47], s85 offen offset:3072 sc1
    v_lshrrev_b32 v46, 1, v47
    v_add_u32 v46, s79, v46
    s_add_u32 s85, s85, 4096
    buffer_load_dwordx4 v[204:207], v253, s[44:47], s85 offen offset:0 sc1
    global_load_dwordx4 v[14:17], v45, s[26:27]
    global_load_dwordx4 v[18:21], v45, s[26:27] offset:64
    s_add_u32 s85, s85, 36864
    buffer_load_dwordx4 v[208:211], v253, s[44:47], s85 offen offset:0 sc1
    global_load_dwordx2 v[22:23], v46, s[26:27] offset:128
    s_movk_i32 s69, 4096
    v_mad_u32_u24 v44, v50, s69, v47
    buffer_load_dwordx4 v[212:215], v253, s[44:47], s85 offen offset:1024 sc1
    v_and_b32 v3, 12, v0
    v_mad_u32_u24 v3, v3, s69, v44
    s_mul_i32 s88, s62, 327680
    s_lshr_b32 s69, s61, 3
    s_lshl_b32 s69, s69, 10
    s_add_u32 s88, s88, s69
    s_and_b32 s69, s68, 15
    s_lshl_b32 s69, s69, 6
    s_add_u32 s88, s88, s69
    s_add_u32 s88, s88, 4194304
    buffer_load_dwordx4 v[216:219], v253, s[44:47], s85 offen offset:2048 sc1
    v_lshlrev_b32 v48, 2, v50
    v_and_b32 v48, 48, v48
    buffer_load_dwordx4 v[220:223], v253, s[44:47], s85 offen offset:3072 sc1
    v_cmp_eq_u32 vcc, v48, v47
    v_and_b32 v48, 1, v0
    s_add_u32 s85, s85, 4096
    buffer_load_dwordx4 v[224:227], v253, s[44:47], s85 offen offset:0 sc1
    v_lshlrev_b32 v48, 4, v48
    v_mov_b32 v49, 0x3f80
    s_add_u32 s85, s85, 36864
    buffer_load_dwordx4 v[228:231], v254, s[44:47], s85 offen offset:0 sc1
    v_lshlrev_b32 v48, v48, v49
    v_cndmask_b32 v51, 0, v48, vcc
    s_bfe_u32 s69, s61, 0x10002
    s_lshl_b32 s69, s69, 1
    buffer_load_dwordx4 v[232:235], v254, s[44:47], s85 offen offset:1024 sc1
    v_bfe_u32 v50, v0, 1, 1
    v_add_u32 v50, s69, v50
    s_mul_i32 s69, s3, 15360
    s_add_u32 s69, s69, 57344
    buffer_load_dwordx4 v[236:239], v254, s[44:47], s85 offen offset:2048 sc1
    v_add_u32 v47, s69, v253
    v_cmp_eq_u32 vcc, 0, v50
    buffer_load_dwordx4 v[240:243], v254, s[44:47], s85 offen offset:3072 sc1
    s_nop 0
    v_cndmask_b32 v48, 0, v51, vcc
    v_cmp_eq_u32 vcc, 1, v50
    s_add_u32 s85, s85, 4096
    buffer_load_dwordx4 v[244:247], v254, s[44:47], s85 offen offset:0 sc1
    v_cndmask_b32 v49, 0, v51, vcc
    v_cmp_eq_u32 vcc, 2, v50
    s_add_u32 s85, s85, 4294717440
    buffer_load_dwordx4 v[108:111], v253, s[44:47], s85 offen offset:0 sc1
    v_cmp_eq_u32 s[70:71], 3, v50
    v_cndmask_b32 v50, 0, v51, vcc
    buffer_load_dwordx4 v[112:115], v253, s[44:47], s85 offen offset:1024 sc1
    v_cndmask_b32 v51, 0, v51, s[70:71]
    buffer_load_dwordx4 v[116:119], v253, s[44:47], s85 offen offset:2048 sc1
    buffer_load_dwordx4 v[120:123], v253, s[44:47], s85 offen offset:3072 sc1
    s_add_u32 s85, s85, 4096
    buffer_load_dwordx4 v[124:127], v253, s[44:47], s85 offen offset:0 sc1
    s_add_u32 s85, s85, 36864
    buffer_load_dwordx4 v[128:131], v253, s[44:47], s85 offen offset:0 sc1
    buffer_load_dwordx4 v[132:135], v253, s[44:47], s85 offen offset:1024 sc1
    buffer_load_dwordx4 v[136:139], v253, s[44:47], s85 offen offset:2048 sc1
    buffer_load_dwordx4 v[140:143], v253, s[44:47], s85 offen offset:3072 sc1
    buffer_load_dword v250, v248, s[44:47], s99 offen sc1
    s_waitcnt vmcnt(19)
    v_sub_f32 v45, 1.0, v1
    v_lshlrev_b32 v4, 16, v14
    v_and_b32 v5, 0xffff0000, v14
    v_lshlrev_b32 v6, 16, v15
    v_and_b32 v7, 0xffff0000, v15
    v_lshlrev_b32 v8, 16, v16
    v_and_b32 v9, 0xffff0000, v16
    v_lshlrev_b32 v10, 16, v17
    v_and_b32 v11, 0xffff0000, v17
    v_lshlrev_b32 v12, 16, v18
    v_and_b32 v13, 0xffff0000, v18
    v_lshlrev_b32 v14, 16, v19
    v_and_b32 v15, 0xffff0000, v19
    v_lshlrev_b32 v16, 16, v20
    v_and_b32 v17, 0xffff0000, v20
    v_lshlrev_b32 v18, 16, v21
    v_and_b32 v19, 0xffff0000, v21
    v_lshlrev_b32 v20, 16, v22
    v_and_b32 v21, 0xffff0000, v22
    v_lshlrev_b32 v22, 16, v23
    v_and_b32 v23, 0xffff0000, v23
    s_barrier
    s_waitcnt vmcnt(0)
    s_mov_b32 s89, 0x20000
gated_mix__ssm_conv_s4d__mixer_channel_mlp__prompt_kernel_sp33:
    v_cmp_ne_u32 s[90:91], v249, v250
    s_sub_u32 s89, s89, 1
    s_cselect_b64 s[90:91], 0, s[90:91]
    s_cmp_eq_u64 s[90:91], 0
    s_cbranch_scc1 gated_mix__ssm_conv_s4d__mixer_channel_mlp__prompt_kernel_sd34
    s_nop 0
    buffer_load_dword v250, v248, s[44:47], s99 offen sc1
    s_waitcnt vmcnt(0)
    s_branch gated_mix__ssm_conv_s4d__mixer_channel_mlp__prompt_kernel_sp33
gated_mix__ssm_conv_s4d__mixer_channel_mlp__prompt_kernel_sd34:
    s_barrier
    s_add_u32 s86, s3, 1
    s_and_b32 s86, s86, 3
    s_lshl2_add_u32 s86, s61, s86
    s_mul_i32 s86, s86, 54
    s_add_u32 s86, s86, s101
    s_lshl_b32 s86, s86, 10
    s_add_u32 s86, s86, 10485760
    buffer_load_dwordx4 v[52:55], v253, s[44:47], s86 offen sc1
    s_add_u32 s86, s86, 8192
    buffer_load_dwordx4 v[56:59], v253, s[44:47], s86 offen sc1
    s_add_u32 s86, s86, 8192
    buffer_load_dwordx4 v[60:63], v253, s[44:47], s86 offen sc1
    s_add_u32 s86, s86, 8192
    buffer_load_dwordx4 v[64:67], v253, s[44:47], s86 offen sc1
    s_add_u32 s86, s86, 8192
    buffer_load_dwordx4 v[68:71], v253, s[44:47], s86 offen sc1
    s_add_u32 s86, s86, 8192
    buffer_load_dwordx4 v[72:75], v253, s[44:47], s86 offen sc1
    s_add_u32 s86, s86, 8192
    buffer_load_dwordx4 v[76:79], v254, s[44:47], s86 offen sc1
    s_add_u32 s86, s3, 2
    s_and_b32 s86, s86, 3
    s_lshl2_add_u32 s86, s61, s86
    s_mul_i32 s86, s86, 54
    s_add_u32 s86, s86, s101
    s_lshl_b32 s86, s86, 10
    s_add_u32 s86, s86, 10485760
    buffer_load_dwordx4 v[80:83], v253, s[44:47], s86 offen sc1
    s_add_u32 s86, s86, 8192
    buffer_load_dwordx4 v[84:87], v253, s[44:47], s86 offen sc1
    s_add_u32 s86, s86, 8192
    buffer_load_dwordx4 v[88:91], v253, s[44:47], s86 offen sc1
    s_cmp_eq_u32 s3, 0
    s_cselect_b32 s89, 2, 0
    v_cmp_gt_u32 s[90:91], s89, v0
    v_lshlrev_b32 v248, 11, v0
    v_mov_b32 v249, 1073741824
    v_cndmask_b32 v248, v249, v248, s[90:91]
    v_cndmask_b32 v249, 0, 32, s[90:91]
    s_lshr_b32 s97, s61, 4
    s_lshl2_add_u32 s97, s62, s97
    s_mul_i32 s99, s97, 4
    s_add_u32 s99, s99, 768
    s_and_b32 s89, s61, 3
    s_add_u32 s99, s99, s89
    s_lshl_b32 s99, s99, 8
    s_waitcnt vmcnt(9)
    v_mfma_f32_16x16x32_bf16 v[4:7], v[108:111], v[52:55], v[4:7]
    v_mfma_f32_16x16x32_bf16 v[8:11], v[112:115], v[52:55], v[8:11]
    s_add_u32 s86, s86, 8192
    buffer_load_dwordx4 v[92:95], v253, s[44:47], s86 offen sc1
    v_mfma_f32_16x16x32_bf16 v[12:15], v[116:119], v[52:55], v[12:15]
    v_mfma_f32_16x16x32_bf16 v[16:19], v[120:123], v[52:55], v[16:19]
    v_mfma_f32_16x16x32_bf16 v[20:23], v[124:127], v[52:55], v[20:23]
    s_waitcnt vmcnt(9)
    v_mfma_f32_16x16x32_bf16 v[4:7], v[128:131], v[56:59], v[4:7]
    v_mfma_f32_16x16x32_bf16 v[8:11], v[132:135], v[56:59], v[8:11]
    s_add_u32 s86, s86, 8192
    buffer_load_dwordx4 v[96:99], v253, s[44:47], s86 offen sc1
    v_mfma_f32_16x16x32_bf16 v[12:15], v[136:139], v[56:59], v[12:15]
    v_mfma_f32_16x16x32_bf16 v[16:19], v[140:143], v[56:59], v[16:19]
    v_mfma_f32_16x16x32_bf16 v[20:23], v[144:147], v[56:59], v[20:23]
    s_waitcnt vmcnt(9)
    v_mfma_f32_16x16x32_bf16 v[4:7], v[148:151], v[60:63], v[4:7]
    v_mfma_f32_16x16x32_bf16 v[8:11], v[152:155], v[60:63], v[8:11]
    s_add_u32 s86, s86, 8192
    buffer_load_dwordx4 v[100:103], v253, s[44:47], s86 offen sc1
    v_mfma_f32_16x16x32_bf16 v[12:15], v[156:159], v[60:63], v[12:15]
    v_mfma_f32_16x16x32_bf16 v[16:19], v[160:163], v[60:63], v[16:19]
    v_mfma_f32_16x16x32_bf16 v[20:23], v[164:167], v[60:63], v[20:23]
    s_waitcnt vmcnt(9)
    v_mfma_f32_16x16x32_bf16 v[4:7], v[168:171], v[64:67], v[4:7]
    v_mfma_f32_16x16x32_bf16 v[8:11], v[172:175], v[64:67], v[8:11]
    s_add_u32 s86, s86, 8192
    buffer_load_dwordx4 v[104:107], v254, s[44:47], s86 offen sc1
    v_mfma_f32_16x16x32_bf16 v[12:15], v[176:179], v[64:67], v[12:15]
    v_mfma_f32_16x16x32_bf16 v[16:19], v[180:183], v[64:67], v[16:19]
    v_mfma_f32_16x16x32_bf16 v[20:23], v[184:187], v[64:67], v[20:23]
    s_waitcnt vmcnt(9)
    v_mfma_f32_16x16x32_bf16 v[4:7], v[188:191], v[68:71], v[4:7]
    v_mfma_f32_16x16x32_bf16 v[8:11], v[192:195], v[68:71], v[8:11]
    s_add_u32 s86, s3, 3
    s_and_b32 s86, s86, 3
    s_lshl2_add_u32 s86, s61, s86
    s_mul_i32 s86, s86, 54
    s_add_u32 s86, s86, s101
    s_lshl_b32 s86, s86, 10
    s_add_u32 s86, s86, 10485760
    buffer_load_dwordx4 v[52:55], v253, s[44:47], s86 offen sc1
    v_mfma_f32_16x16x32_bf16 v[12:15], v[196:199], v[68:71], v[12:15]
    v_mfma_f32_16x16x32_bf16 v[16:19], v[200:203], v[68:71], v[16:19]
    v_mfma_f32_16x16x32_bf16 v[20:23], v[204:207], v[68:71], v[20:23]
    s_waitcnt vmcnt(9)
    v_mfma_f32_16x16x32_bf16 v[4:7], v[208:211], v[72:75], v[4:7]
    v_mfma_f32_16x16x32_bf16 v[8:11], v[212:215], v[72:75], v[8:11]
    s_add_u32 s86, s86, 8192
    buffer_load_dwordx4 v[56:59], v253, s[44:47], s86 offen sc1
    v_mfma_f32_16x16x32_bf16 v[12:15], v[216:219], v[72:75], v[12:15]
    v_mfma_f32_16x16x32_bf16 v[16:19], v[220:223], v[72:75], v[16:19]
    v_mfma_f32_16x16x32_bf16 v[20:23], v[224:227], v[72:75], v[20:23]
    s_waitcnt vmcnt(9)
    v_mfma_f32_16x16x32_bf16 v[4:7], v[228:231], v[76:79], v[4:7]
    v_mfma_f32_16x16x32_bf16 v[8:11], v[232:235], v[76:79], v[8:11]
    s_add_u32 s86, s86, 8192
    buffer_load_dwordx4 v[60:63], v253, s[44:47], s86 offen sc1
    v_mfma_f32_16x16x32_bf16 v[12:15], v[236:239], v[76:79], v[12:15]
    v_mfma_f32_16x16x32_bf16 v[16:19], v[240:243], v[76:79], v[16:19]
    v_mfma_f32_16x16x32_bf16 v[20:23], v[244:247], v[76:79], v[20:23]
    s_waitcnt vmcnt(9)
    v_mfma_f32_16x16x32_bf16 v[24:27], v[108:111], v[80:83], 0
    v_mfma_f32_16x16x32_bf16 v[28:31], v[112:115], v[80:83], 0
    s_add_u32 s86, s86, 8192
    buffer_load_dwordx4 v[64:67], v253, s[44:47], s86 offen sc1
    v_mfma_f32_16x16x32_bf16 v[32:35], v[116:119], v[80:83], 0
    ds_write_b128 v2, v[4:7] offset:0
    v_mfma_f32_16x16x32_bf16 v[36:39], v[120:123], v[80:83], 0
    ds_write_b128 v2, v[8:11] offset:1024
    v_mfma_f32_16x16x32_bf16 v[40:43], v[124:127], v[80:83], 0
    ds_write_b128 v2, v[12:15] offset:2048
    s_waitcnt vmcnt(9)
    v_mfma_f32_16x16x32_bf16 v[24:27], v[128:131], v[84:87], v[24:27]
    ds_write_b128 v2, v[16:19] offset:3072
    v_mfma_f32_16x16x32_bf16 v[28:31], v[132:135], v[84:87], v[28:31]
    ds_write_b128 v2, v[20:23] offset:4096
    s_add_u32 s86, s86, 8192
    buffer_load_dwordx4 v[68:71], v253, s[44:47], s86 offen sc1
    v_mfma_f32_16x16x32_bf16 v[32:35], v[136:139], v[84:87], v[32:35]
    v_mfma_f32_16x16x32_bf16 v[36:39], v[140:143], v[84:87], v[36:39]
    v_mfma_f32_16x16x32_bf16 v[40:43], v[144:147], v[84:87], v[40:43]
    s_waitcnt lgkmcnt(0)
    s_barrier
    s_waitcnt vmcnt(9)
    v_mfma_f32_16x16x32_bf16 v[24:27], v[148:151], v[88:91], v[24:27]
    v_mfma_f32_16x16x32_bf16 v[28:31], v[152:155], v[88:91], v[28:31]
    s_add_u32 s86, s86, 8192
    buffer_load_dwordx4 v[72:75], v253, s[44:47], s86 offen sc1
    v_mfma_f32_16x16x32_bf16 v[32:35], v[156:159], v[88:91], v[32:35]
    v_mfma_f32_16x16x32_bf16 v[36:39], v[160:163], v[88:91], v[36:39]
    v_mfma_f32_16x16x32_bf16 v[40:43], v[164:167], v[88:91], v[40:43]
    s_waitcnt vmcnt(9)
    v_mfma_f32_16x16x32_bf16 v[24:27], v[168:171], v[92:95], v[24:27]
    v_mfma_f32_16x16x32_bf16 v[28:31], v[172:175], v[92:95], v[28:31]
    s_add_u32 s86, s86, 8192
    buffer_load_dwordx4 v[76:79], v254, s[44:47], s86 offen sc1
    v_mfma_f32_16x16x32_bf16 v[32:35], v[176:179], v[92:95], v[32:35]
    v_mfma_f32_16x16x32_bf16 v[36:39], v[180:183], v[92:95], v[36:39]
    v_mfma_f32_16x16x32_bf16 v[40:43], v[184:187], v[92:95], v[40:43]
    s_waitcnt vmcnt(9)
    v_mfma_f32_16x16x32_bf16 v[24:27], v[188:191], v[96:99], v[24:27]
    v_mfma_f32_16x16x32_bf16 v[28:31], v[192:195], v[96:99], v[28:31]
    s_add_u32 s86, s3, 4
    s_and_b32 s86, s86, 3
    s_lshl2_add_u32 s86, s61, s86
    s_mul_i32 s86, s86, 54
    s_add_u32 s86, s86, s101
    s_lshl_b32 s86, s86, 10
    s_add_u32 s86, s86, 10485760
    buffer_load_dwordx4 v[80:83], v253, s[44:47], s86 offen sc1
    v_mfma_f32_16x16x32_bf16 v[32:35], v[196:199], v[96:99], v[32:35]
    v_mfma_f32_16x16x32_bf16 v[36:39], v[200:203], v[96:99], v[36:39]
    v_mfma_f32_16x16x32_bf16 v[40:43], v[204:207], v[96:99], v[40:43]
    s_waitcnt vmcnt(9)
    v_mfma_f32_16x16x32_bf16 v[24:27], v[208:211], v[100:103], v[24:27]
    v_mfma_f32_16x16x32_bf16 v[28:31], v[212:215], v[100:103], v[28:31]
    s_add_u32 s86, s86, 8192
    buffer_load_dwordx4 v[84:87], v253, s[44:47], s86 offen sc1
    v_mfma_f32_16x16x32_bf16 v[32:35], v[216:219], v[100:103], v[32:35]
    v_mfma_f32_16x16x32_bf16 v[36:39], v[220:223], v[100:103], v[36:39]
    v_mfma_f32_16x16x32_bf16 v[40:43], v[224:227], v[100:103], v[40:43]
    s_waitcnt vmcnt(9)
    v_mfma_f32_16x16x32_bf16 v[24:27], v[228:231], v[104:107], v[24:27]
    v_mfma_f32_16x16x32_bf16 v[28:31], v[232:235], v[104:107], v[28:31]
    s_add_u32 s86, s86, 8192
    buffer_load_dwordx4 v[88:91], v253, s[44:47], s86 offen sc1
    v_mfma_f32_16x16x32_bf16 v[32:35], v[236:239], v[104:107], v[32:35]
    v_mfma_f32_16x16x32_bf16 v[36:39], v[240:243], v[104:107], v[36:39]
    v_mfma_f32_16x16x32_bf16 v[40:43], v[244:247], v[104:107], v[40:43]
    s_waitcnt vmcnt(9)
    v_mfma_f32_16x16x32_bf16 v[4:7], v[108:111], v[52:55], 0
    v_mfma_f32_16x16x32_bf16 v[8:11], v[112:115], v[52:55], 0
    s_add_u32 s86, s86, 8192
    buffer_load_dwordx4 v[92:95], v253, s[44:47], s86 offen sc1
    v_mfma_f32_16x16x32_bf16 v[12:15], v[116:119], v[52:55], 0
    ds_write_b128 v2, v[24:27] offset:20480
    v_mfma_f32_16x16x32_bf16 v[16:19], v[120:123], v[52:55], 0
    ds_write_b128 v2, v[28:31] offset:21504
    v_mfma_f32_16x16x32_bf16 v[20:23], v[124:127], v[52:55], 0
    ds_write_b128 v2, v[32:35] offset:22528
    s_waitcnt vmcnt(9)
    v_mfma_f32_16x16x32_bf16 v[4:7], v[128:131], v[56:59], v[4:7]
    ds_write_b128 v2, v[36:39] offset:23552
    v_mfma_f32_16x16x32_bf16 v[8:11], v[132:135], v[56:59], v[8:11]
    ds_write_b128 v2, v[40:43] offset:24576
    s_add_u32 s86, s86, 8192
    buffer_load_dwordx4 v[96:99], v253, s[44:47], s86 offen sc1
    v_mfma_f32_16x16x32_bf16 v[12:15], v[136:139], v[56:59], v[12:15]
    v_mfma_f32_16x16x32_bf16 v[16:19], v[140:143], v[56:59], v[16:19]
    v_mfma_f32_16x16x32_bf16 v[20:23], v[144:147], v[56:59], v[20:23]
    s_waitcnt lgkmcnt(0)
    s_barrier
    s_waitcnt vmcnt(9)
    v_mfma_f32_16x16x32_bf16 v[4:7], v[148:151], v[60:63], v[4:7]
    v_mfma_f32_16x16x32_bf16 v[8:11], v[152:155], v[60:63], v[8:11]
    s_add_u32 s86, s86, 8192
    buffer_load_dwordx4 v[100:103], v253, s[44:47], s86 offen sc1
    v_mfma_f32_16x16x32_bf16 v[12:15], v[156:159], v[60:63], v[12:15]
    v_mfma_f32_16x16x32_bf16 v[16:19], v[160:163], v[60:63], v[16:19]
    v_mfma_f32_16x16x32_bf16 v[20:23], v[164:167], v[60:63], v[20:23]
    s_waitcnt vmcnt(9)
    v_mfma_f32_16x16x32_bf16 v[4:7], v[168:171], v[64:67], v[4:7]
    v_mfma_f32_16x16x32_bf16 v[8:11], v[172:175], v[64:67], v[8:11]
    s_add_u32 s86, s86, 8192
    buffer_load_dwordx4 v[104:107], v254, s[44:47], s86 offen sc1
    v_mfma_f32_16x16x32_bf16 v[12:15], v[176:179], v[64:67], v[12:15]
    v_mfma_f32_16x16x32_bf16 v[16:19], v[180:183], v[64:67], v[16:19]
    v_mfma_f32_16x16x32_bf16 v[20:23], v[184:187], v[64:67], v[20:23]
    s_waitcnt vmcnt(9)
    v_mfma_f32_16x16x32_bf16 v[4:7], v[188:191], v[68:71], v[4:7]
    v_mfma_f32_16x16x32_bf16 v[8:11], v[192:195], v[68:71], v[8:11]
    v_mfma_f32_16x16x32_bf16 v[12:15], v[196:199], v[68:71], v[12:15]
    v_mfma_f32_16x16x32_bf16 v[16:19], v[200:203], v[68:71], v[16:19]
    v_mfma_f32_16x16x32_bf16 v[20:23], v[204:207], v[68:71], v[20:23]
    buffer_load_dword v250, v248, s[44:47], s99 offen sc1
    s_waitcnt vmcnt(9)
    v_mfma_f32_16x16x32_bf16 v[4:7], v[208:211], v[72:75], v[4:7]
    v_mfma_f32_16x16x32_bf16 v[8:11], v[212:215], v[72:75], v[8:11]
    v_mfma_f32_16x16x32_bf16 v[12:15], v[216:219], v[72:75], v[12:15]
    v_mfma_f32_16x16x32_bf16 v[16:19], v[220:223], v[72:75], v[16:19]
    v_mfma_f32_16x16x32_bf16 v[20:23], v[224:227], v[72:75], v[20:23]
    s_waitcnt vmcnt(8)
    v_mfma_f32_16x16x32_bf16 v[4:7], v[228:231], v[76:79], v[4:7]
    v_mfma_f32_16x16x32_bf16 v[8:11], v[232:235], v[76:79], v[8:11]
    v_mfma_f32_16x16x32_bf16 v[12:15], v[236:239], v[76:79], v[12:15]
    v_mfma_f32_16x16x32_bf16 v[16:19], v[240:243], v[76:79], v[16:19]
    v_mfma_f32_16x16x32_bf16 v[20:23], v[244:247], v[76:79], v[20:23]
    s_waitcnt vmcnt(7)
    v_mfma_f32_16x16x32_bf16 v[24:27], v[108:111], v[80:83], 0
    v_mfma_f32_16x16x32_bf16 v[28:31], v[112:115], v[80:83], 0
    v_mfma_f32_16x16x32_bf16 v[32:35], v[116:119], v[80:83], 0
    ds_write_b128 v2, v[4:7] offset:0
    v_mfma_f32_16x16x32_bf16 v[36:39], v[120:123], v[80:83], 0
    ds_write_b128 v2, v[8:11] offset:1024
    v_mfma_f32_16x16x32_bf16 v[40:43], v[124:127], v[80:83], 0
    ds_write_b128 v2, v[12:15] offset:2048
    s_waitcnt vmcnt(6)
    v_mfma_f32_16x16x32_bf16 v[24:27], v[128:131], v[84:87], v[24:27]
    ds_write_b128 v2, v[16:19] offset:3072
    v_mfma_f32_16x16x32_bf16 v[28:31], v[132:135], v[84:87], v[28:31]
    ds_write_b128 v2, v[20:23] offset:4096
    v_mfma_f32_16x16x32_bf16 v[32:35], v[136:139], v[84:87], v[32:35]
    v_mfma_f32_16x16x32_bf16 v[36:39], v[140:143], v[84:87], v[36:39]
    v_mfma_f32_16x16x32_bf16 v[40:43], v[144:147], v[84:87], v[40:43]
    s_waitcnt vmcnt(0)
    s_mov_b32 s89, 0x20000
gated_mix__ssm_conv_s4d__mixer_channel_mlp__prompt_kernel_sp35:
    v_cmp_ne_u32 s[90:91], v249, v250
    s_sub_u32 s89, s89, 1
    s_cselect_b64 s[90:91], 0, s[90:91]
    s_cmp_eq_u64 s[90:91], 0
    s_cbranch_scc1 gated_mix__ssm_conv_s4d__mixer_channel_mlp__prompt_kernel_sd36
    s_nop 0
    buffer_load_dword v250, v248, s[44:47], s99 offen sc1
    s_waitcnt vmcnt(0)
    s_branch gated_mix__ssm_conv_s4d__mixer_channel_mlp__prompt_kernel_sp35
gated_mix__ssm_conv_s4d__mixer_channel_mlp__prompt_kernel_sd36:
    s_waitcnt lgkmcnt(0)
    s_barrier
    s_waitcnt vmcnt(5)
    v_mfma_f32_16x16x32_bf16 v[24:27], v[148:151], v[88:91], v[24:27]
    buffer_load_dwordx4 v[52:55], v3, s[44:47], s88 offen sc1
    v_mfma_f32_16x16x32_bf16 v[28:31], v[152:155], v[88:91], v[28:31]
    s_add_u32 s88, s88, 16384
    buffer_load_dwordx4 v[56:59], v3, s[44:47], s88 offen sc1
    v_mfma_f32_16x16x32_bf16 v[32:35], v[156:159], v[88:91], v[32:35]
    s_add_u32 s88, s88, 114688
    buffer_load_dwordx4 v[60:63], v3, s[44:47], s88 offen sc1
    v_mfma_f32_16x16x32_bf16 v[36:39], v[160:163], v[88:91], v[36:39]
    s_add_u32 s88, s88, 16384
    buffer_load_dwordx4 v[64:67], v3, s[44:47], s88 offen sc1
    v_mfma_f32_16x16x32_bf16 v[40:43], v[164:167], v[88:91], v[40:43]
    s_add_u32 s88, s88, 114688
    buffer_load_dwordx4 v[68:71], v44, s[44:47], s88 offen sc1
    s_waitcnt vmcnt(9)
    v_mfma_f32_16x16x32_bf16 v[24:27], v[168:171], v[92:95], v[24:27]
    ds_read_b128 v[4:7], v47 offset:0
    v_mfma_f32_16x16x32_bf16 v[28:31], v[172:175], v[92:95], v[28:31]
    ds_read_b128 v[8:11], v47 offset:1024
    v_mfma_f32_16x16x32_bf16 v[32:35], v[176:179], v[92:95], v[32:35]
    ds_read_b128 v[12:15], v47 offset:2048
    v_mfma_f32_16x16x32_bf16 v[36:39], v[180:183], v[92:95], v[36:39]
    ds_read_b128 v[16:19], v47 offset:3072
    v_mfma_f32_16x16x32_bf16 v[40:43], v[184:187], v[92:95], v[40:43]
    ds_read_b128 v[20:23], v47 offset:4096
    s_waitcnt vmcnt(8)
    v_mfma_f32_16x16x32_bf16 v[24:27], v[188:191], v[96:99], v[24:27]
    v_mfma_f32_16x16x32_bf16 v[28:31], v[192:195], v[96:99], v[28:31]
    v_mfma_f32_16x16x32_bf16 v[32:35], v[196:199], v[96:99], v[32:35]
    v_mfma_f32_16x16x32_bf16 v[36:39], v[200:203], v[96:99], v[36:39]
    v_mfma_f32_16x16x32_bf16 v[40:43], v[204:207], v[96:99], v[40:43]
    s_waitcnt vmcnt(7)
    v_mfma_f32_16x16x32_bf16 v[24:27], v[208:211], v[100:103], v[24:27]
    s_waitcnt lgkmcnt(0)
    v_mul_f32 v4, v45, v4
    v_mul_f32 v5, v45, v5
    v_mfma_f32_16x16x32_bf16 v[28:31], v[212:215], v[100:103], v[28:31]
    v_mul_f32 v6, v45, v6
    v_mul_f32 v7, v45, v7
    v_mfma_f32_16x16x32_bf16 v[32:35], v[216:219], v[100:103], v[32:35]
    v_mul_f32 v8, v45, v8
    v_mul_f32 v9, v45, v9
    v_mfma_f32_16x16x32_bf16 v[36:39], v[220:223], v[100:103], v[36:39]
    v_mul_f32 v10, v45, v10
    v_mul_f32 v11, v45, v11
    v_mfma_f32_16x16x32_bf16 v[40:43], v[224:227], v[100:103], v[40:43]
    v_mul_f32 v12, v45, v12
    v_mul_f32 v13, v45, v13
    s_waitcnt vmcnt(6)
    v_mfma_f32_16x16x32_bf16 v[24:27], v[228:231], v[104:107], v[24:27]
    v_mul_f32 v14, v45, v14
    v_mul_f32 v15, v45, v15
    v_mfma_f32_16x16x32_bf16 v[28:31], v[232:235], v[104:107], v[28:31]
    v_mul_f32 v16, v45, v16
    v_mul_f32 v17, v45, v17
    v_mfma_f32_16x16x32_bf16 v[32:35], v[236:239], v[104:107], v[32:35]
    v_mul_f32 v18, v45, v18
    v_mul_f32 v19, v45, v19
    v_mfma_f32_16x16x32_bf16 v[36:39], v[240:243], v[104:107], v[36:39]
    v_mul_f32 v20, v45, v20
    v_mul_f32 v21, v45, v21
    v_mfma_f32_16x16x32_bf16 v[40:43], v[244:247], v[104:107], v[40:43]
    v_mul_f32 v22, v45, v22
    v_mul_f32 v23, v45, v23
    v_add_u32 v2, 102400, v2
    v_fmac_f32 v4, v45, v24
    v_fmac_f32 v5, v45, v25
    v_fmac_f32 v6, v45, v26
    v_fmac_f32 v7, v45, v27
    v_fmac_f32 v8, v45, v28
    v_fmac_f32 v9, v45, v29
    v_fmac_f32 v10, v45, v30
    v_fmac_f32 v11, v45, v31
    v_fmac_f32 v12, v45, v32
    v_fmac_f32 v13, v45, v33
    v_fmac_f32 v14, v45, v34
    v_fmac_f32 v15, v45, v35
    v_fmac_f32 v16, v45, v36
    v_fmac_f32 v17, v45, v37
    v_fmac_f32 v18, v45, v38
    v_fmac_f32 v19, v45, v39
    v_fmac_f32 v20, v45, v40
    v_fmac_f32 v21, v45, v41
    v_fmac_f32 v22, v45, v42
    v_fmac_f32 v23, v45, v43
    s_barrier
    s_waitcnt vmcnt(0)
    v_mfma_f32_16x16x32_bf16 v[148:151], v[52:55], v[48:51], 0
    v_mfma_f32_16x16x32_bf16 v[152:155], v[56:59], v[48:51], 0
    v_mfma_f32_16x16x32_bf16 v[156:159], v[60:63], v[48:51], 0
    v_mfma_f32_16x16x32_bf16 v[160:163], v[64:67], v[48:51], 0
    v_mfma_f32_16x16x32_bf16 v[164:167], v[68:71], v[48:51], 0
    s_nop 3
    v_fmac_f32 v4, v1, v148
    v_fmac_f32 v5, v1, v149
    v_fmac_f32 v6, v1, v150
    v_fmac_f32 v7, v1, v151
    ds_write_b128 v2, v[4:7] offset:0
    v_fmac_f32 v8, v1, v152
    v_fmac_f32 v9, v1, v153
    v_fmac_f32 v10, v1, v154
    v_fmac_f32 v11, v1, v155
    ds_write_b128 v2, v[8:11] offset:1024
    v_fmac_f32 v12, v1, v156
    v_fmac_f32 v13, v1, v157
    v_fmac_f32 v14, v1, v158
    v_fmac_f32 v15, v1, v159
    ds_write_b128 v2, v[12:15] offset:2048
    v_fmac_f32 v16, v1, v160
    v_fmac_f32 v17, v1, v161
    v_fmac_f32 v18, v1, v162
    v_fmac_f32 v19, v1, v163
    ds_write_b128 v2, v[16:19] offset:3072
    v_fmac_f32 v20, v1, v164
    v_fmac_f32 v21, v1, v165
    v_fmac_f32 v22, v1, v166
    v_fmac_f32 v23, v1, v167
    ds_write_b128 v2, v[20:23] offset:4096
    s_waitcnt lgkmcnt(0)
    s_barrier
gated_mix__ssm_conv_s4d__mixer_channel_mlp__prompt_kernel_fin:
gated_mix__ssm_conv_s4d__mixer_channel_mlp__prompt_kernel_end:
    s_endpgm
.section .rodata,"a"
.p2align 6
.amdhsa_kernel gated_mix__ssm_conv_s4d__mixer_channel_mlp__prompt_kernel
  .amdhsa_next_free_vgpr 256
  .amdhsa_next_free_sgpr 102
  .amdhsa_accum_offset 256
  .amdhsa_group_segment_fixed_size 0
  .amdhsa_kernarg_size 128
  .amdhsa_user_sgpr_count 2
  .amdhsa_user_sgpr_kernarg_segment_ptr 1
  .amdhsa_system_sgpr_workgroup_id_x 1
  .amdhsa_float_denorm_mode_32 3
.end_amdhsa_kernel
```
